```python
import torch

def _softmax(x, axis=-1):
    return torch.softmax(x, dim=axis)
def _gelu(x):
    return torch.nn.functional.gelu(x, approximate="tanh")
def _silu(x):
    return torch.nn.functional.silu(x)
def _sigmoid(x):
    return torch.sigmoid(x)
def _layernorm(x, axis=-1, eps=1e-5):
    m = x.mean(dim=axis, keepdim=True)
    v = x.var(dim=axis, keepdim=True, unbiased=False)
    return (x - m) / torch.sqrt(v + eps)
def _scatter_add(tgt, idx, src, axis=0):
    return tgt.clone().index_add_(axis, idx, src)
def _segment_sum(src, seg, n):
    out = torch.zeros((n,) + src.shape[1:], dtype=src.dtype)
    return out.index_add_(0, seg, src)
def _pad(x, pw):
    flat = tuple(v for pair in reversed(pw) for v in pair)
    return torch.nn.functional.pad(x, flat)

kernel_name = 'recurrent_scan__grouped_kv_mqa__dense_activation_squared_relu__prompt'

def setup_inputs():

    _w = (lambda a: (lambda t: t.to(torch.bfloat16) if t.is_floating_point() else t)(torch.as_tensor(a)))
    def _A_setup():
        B, S, D, H = 1, 2048, 512, 32
        Dh = D // H
        return {
            "x": _w((lambda *s: torch.randn(*s, dtype=torch.bfloat16) * 0.05)(B, S, D)),
            "wq": _w((lambda *s: torch.randn(*s, dtype=torch.bfloat16) * 0.05)(D, H * Dh)),
            "wk": _w((lambda *s: torch.randn(*s, dtype=torch.bfloat16) * 0.05)(D, Dh)),
            "wv": _w((lambda *s: torch.randn(*s, dtype=torch.bfloat16) * 0.05)(D, Dh)),
            "wo": _w((lambda *s: torch.randn(*s, dtype=torch.bfloat16) * 0.05)(H * Dh, D)),
        }
    _A_in = _A_setup()

    def _B_setup():
        B, S, D, F = 1, 2048, 512, 1792
        return {
            "x": _w((lambda *s: torch.randn(*s, dtype=torch.bfloat16) * 0.05)(B, S, D)),
            "w1": _w((lambda *s: torch.randn(*s, dtype=torch.bfloat16) * 0.05)(D, F)),
            "b1": _w((lambda *s: torch.randn(*s, dtype=torch.bfloat16) * 0.4)(F)),
            "w2": _w((lambda *s: torch.randn(*s, dtype=torch.bfloat16) * 0.05)(F, D)),
            "b2": _w((lambda *s: torch.randn(*s, dtype=torch.bfloat16) * 1.6)(D)),
        }
    _B_in = _B_setup()

    return {
        "A_x": _A_in["x"],
        "A_wq": _A_in["wq"],
        "A_wk": _A_in["wk"],
        "A_wv": _A_in["wv"],
        "A_wo": _A_in["wo"],
        "B_x": _B_in["x"],
        "B_w1": _B_in["w1"],
        "B_b1": _B_in["b1"],
        "B_w2": _B_in["w2"],
        "B_b2": _B_in["b2"],
    }

def reference(A_x, A_wq, A_wk, A_wv, A_wo, B_x, B_w1, B_b1, B_w2, B_b2):
    def _A_ref(x, wq, wk, wv, wo):
        B, S, D = x.shape
        H = 32
        Dh = D // H
        q = (lambda x, *d: x.permute(*d))((x @ wq).reshape(B, S, H, Dh), 0, 2, 1, 3)
        k = x @ wk
        v = x @ wv
        scores = torch.einsum("bhqd,bkd->bhqk", q, k) * (Dh ** -0.5)
        p = _softmax(scores, axis=-1)
        o = torch.einsum("bhqk,bkd->bhqd", p, v)
        return (lambda x, *d: x.permute(*d))(o, 0, 2, 1, 3).reshape(B, S, H * Dh) @ wo

    def _B_ref(x, w1, b1, w2, b2):
        h = torch.einsum("bsd,df->bsf", x, w1) + b1
        zero = torch.zeros_like(h)
        r = torch.where(h > zero, h, zero)
        h = r * r
        out = torch.einsum("bsf,fd->bsd", h, w2) + b2
        return out

    x = A_x
    xn = _layernorm(x, axis=-1)
    s = _A_ref(xn, A_wq, A_wk, A_wv, A_wo)
    g = _silu(_B_ref(xn, B_w1, B_b1, B_w2, B_b2))
    return x + s * g
```

```asm
; @launch grid=(256,1,1) block=(768,1,1) lds=160000
.amdgcn_target "amdgcn-amd-amdhsa--gfx950"
.text
.globl recurrent_scan__grouped_kv_mqa__dense_activation_squared_relu__prompt_kernel
.p2align 12
.p2align 8
.type recurrent_scan__grouped_kv_mqa__dense_activation_squared_relu__prompt_kernel,@function
recurrent_scan__grouped_kv_mqa__dense_activation_squared_relu__prompt_kernel:
    s_cmp_ge_u32 s2, 256
    s_cbranch_scc1 L_exit
    s_load_dwordx16 s[16:31], s[0:1], 0
    s_load_dwordx8 s[32:39], s[0:1], 64
    s_load_dwordx2 s[40:41], s[0:1], 96
    v_lshrrev_b32 v1, 6, v0
    v_and_b32 v0, 63, v0
    v_readfirstlane_b32 s3, v1
    s_getpc_b64 s[52:53]
L_pc:
    s_cmp_lg_u32 s3, 0
    s_cbranch_scc1 L_nopf
    s_sub_u32 s52, s52, L_pc-recurrent_scan__grouped_kv_mqa__dense_activation_squared_relu__prompt_kernel
    s_subb_u32 s53, s53, 0
    s_mov_b32 s54, L_codeend-recurrent_scan__grouped_kv_mqa__dense_activation_squared_relu__prompt_kernel
    s_mov_b32 s55, 0x20000
    v_lshlrev_b32 v1, 9, v0
    s_bfe_u32 s12, s2, 0x20003
    s_lshl_b32 s12, s12, 7
    buffer_load_dword v163, v1, s[52:55], s12 offen
L_nopf:
    s_and_b32 s12, s2, 1
    s_lshl_b32 s12, s12, 2
    s_bfe_u32 s13, s2, 0x20003
    s_or_b32 s5, s12, s13
    s_bfe_u32 s12, s2, 0x20001
    s_lshl_b32 s12, s12, 3
    s_lshr_b32 s13, s2, 5
    s_or_b32 s4, s12, s13
    s_and_b32 s42, s4, 7
    s_lshl_b32 s43, s5, 1
    s_add_u32 s43, s43, s42
    s_and_b32 s43, s43, 7
    s_and_b32 s42, s42, 6
    s_bfe_u32 s12, s4, 0x10003
    s_or_b32 s42, s42, s12
    s_cmp_ge_u32 s3, 8
    s_cbranch_scc1 L_G
    v_lshrrev_b32 v1, 3, v0
    v_and_b32 v2, 7, v0
    v_lshlrev_b32 v2, 4, v2
    v_mul_u32_u24 v3, 1040, v1
    v_add_u32 v3, v3, v2
    v_lshl_add_u32 v2, v1, 10, v2
    v_lshlrev_b32 v1, 4, v0
    s_lshl_b32 s12, s4, 16
    s_lshl_b32 s13, s3, 13
    s_add_u32 s12, s12, s13
    s_waitcnt lgkmcnt(0)
    s_mov_b32 s44, s16
    s_mov_b32 s45, s17
    s_mov_b32 s46, 2097152
    s_mov_b32 s47, 0x20000
    s_add_u32 s13, s42, 0
    s_and_b32 s13, s13, 7
    s_lshl_b32 s13, s13, 7
    s_add_u32 s13, s13, s12
    buffer_load_dwordx4 v[4:7], v2, s[44:47], s13 offen
    s_add_u32 s13, s42, 1
    s_and_b32 s13, s13, 7
    s_lshl_b32 s13, s13, 7
    s_add_u32 s13, s13, s12
    buffer_load_dwordx4 v[8:11], v2, s[44:47], s13 offen
    s_add_u32 s13, s42, 2
    s_and_b32 s13, s13, 7
    s_lshl_b32 s13, s13, 7
    s_add_u32 s13, s13, s12
    buffer_load_dwordx4 v[12:15], v2, s[44:47], s13 offen
    s_add_u32 s13, s42, 3
    s_and_b32 s13, s13, 7
    s_lshl_b32 s13, s13, 7
    s_add_u32 s13, s13, s12
    buffer_load_dwordx4 v[16:19], v2, s[44:47], s13 offen
    s_add_u32 s13, s42, 4
    s_and_b32 s13, s13, 7
    s_lshl_b32 s13, s13, 7
    s_add_u32 s13, s13, s12
    buffer_load_dwordx4 v[20:23], v2, s[44:47], s13 offen
    s_add_u32 s13, s42, 5
    s_and_b32 s13, s13, 7
    s_lshl_b32 s13, s13, 7
    s_add_u32 s13, s13, s12
    buffer_load_dwordx4 v[24:27], v2, s[44:47], s13 offen
    s_add_u32 s13, s42, 6
    s_and_b32 s13, s13, 7
    s_lshl_b32 s13, s13, 7
    s_add_u32 s13, s13, s12
    buffer_load_dwordx4 v[28:31], v2, s[44:47], s13 offen
    s_add_u32 s13, s42, 7
    s_and_b32 s13, s13, 7
    s_lshl_b32 s13, s13, 7
    s_add_u32 s13, s13, s12
    buffer_load_dwordx4 v[32:35], v2, s[44:47], s13 offen
    s_barrier
    s_load_dword s6, s[40:41], 0
    s_mov_b32 s8, s40
    s_mov_b32 s9, s41
    s_mov_b32 s10, 16777216
    s_mov_b32 s11, 0x20000
    s_lshl_b32 s14, s5, 3
    s_add_u32 s13, s3, s14
    s_lshl_b32 s13, s13, 10
    s_lshl_b32 s14, s4, 16
    s_add_u32 s13, s13, s14
    s_add_u32 s60, s13, 1048576
    s_mul_i32 s13, s3, 8320
    v_add_u32 v3, s13, v3
    s_waitcnt vmcnt(7)
    v_lshlrev_b32 v36, 16, v4
    v_and_b32 v37, 0xffff0000, v4
    v_pk_mul_f32 v[166:167], v[36:37], v[36:37]
    v_lshlrev_b32 v38, 16, v5
    v_and_b32 v39, 0xffff0000, v5
    v_pk_fma_f32 v[166:167], v[38:39], v[38:39], v[166:167]
    v_pk_add_f32 v[164:165], v[38:39], v[36:37]
    v_lshlrev_b32 v40, 16, v6
    v_and_b32 v41, 0xffff0000, v6
    v_pk_fma_f32 v[166:167], v[40:41], v[40:41], v[166:167]
    v_pk_add_f32 v[164:165], v[40:41], v[164:165]
    v_lshlrev_b32 v42, 16, v7
    v_and_b32 v43, 0xffff0000, v7
    v_pk_fma_f32 v[166:167], v[42:43], v[42:43], v[166:167]
    v_pk_add_f32 v[164:165], v[42:43], v[164:165]
    s_waitcnt vmcnt(6)
    v_lshlrev_b32 v44, 16, v8
    v_and_b32 v45, 0xffff0000, v8
    v_pk_fma_f32 v[166:167], v[44:45], v[44:45], v[166:167]
    v_pk_add_f32 v[164:165], v[44:45], v[164:165]
    v_lshlrev_b32 v46, 16, v9
    v_and_b32 v47, 0xffff0000, v9
    v_pk_fma_f32 v[166:167], v[46:47], v[46:47], v[166:167]
    v_pk_add_f32 v[164:165], v[46:47], v[164:165]
    v_lshlrev_b32 v48, 16, v10
    v_and_b32 v49, 0xffff0000, v10
    v_pk_fma_f32 v[166:167], v[48:49], v[48:49], v[166:167]
    v_pk_add_f32 v[164:165], v[48:49], v[164:165]
    v_lshlrev_b32 v50, 16, v11
    v_and_b32 v51, 0xffff0000, v11
    v_pk_fma_f32 v[166:167], v[50:51], v[50:51], v[166:167]
    v_pk_add_f32 v[164:165], v[50:51], v[164:165]
    s_waitcnt vmcnt(5)
    v_lshlrev_b32 v52, 16, v12
    v_and_b32 v53, 0xffff0000, v12
    v_pk_fma_f32 v[166:167], v[52:53], v[52:53], v[166:167]
    v_pk_add_f32 v[164:165], v[52:53], v[164:165]
    v_lshlrev_b32 v54, 16, v13
    v_and_b32 v55, 0xffff0000, v13
    v_pk_fma_f32 v[166:167], v[54:55], v[54:55], v[166:167]
    v_pk_add_f32 v[164:165], v[54:55], v[164:165]
    v_lshlrev_b32 v56, 16, v14
    v_and_b32 v57, 0xffff0000, v14
    v_pk_fma_f32 v[166:167], v[56:57], v[56:57], v[166:167]
    v_pk_add_f32 v[164:165], v[56:57], v[164:165]
    v_lshlrev_b32 v58, 16, v15
    v_and_b32 v59, 0xffff0000, v15
    v_pk_fma_f32 v[166:167], v[58:59], v[58:59], v[166:167]
    v_pk_add_f32 v[164:165], v[58:59], v[164:165]
    s_waitcnt vmcnt(4)
    v_lshlrev_b32 v60, 16, v16
    v_and_b32 v61, 0xffff0000, v16
    v_pk_fma_f32 v[166:167], v[60:61], v[60:61], v[166:167]
    v_pk_add_f32 v[164:165], v[60:61], v[164:165]
    v_lshlrev_b32 v62, 16, v17
    v_and_b32 v63, 0xffff0000, v17
    v_pk_fma_f32 v[166:167], v[62:63], v[62:63], v[166:167]
    v_pk_add_f32 v[164:165], v[62:63], v[164:165]
    v_lshlrev_b32 v64, 16, v18
    v_and_b32 v65, 0xffff0000, v18
    v_pk_fma_f32 v[166:167], v[64:65], v[64:65], v[166:167]
    v_pk_add_f32 v[164:165], v[64:65], v[164:165]
    v_lshlrev_b32 v66, 16, v19
    v_and_b32 v67, 0xffff0000, v19
    v_pk_fma_f32 v[166:167], v[66:67], v[66:67], v[166:167]
    v_pk_add_f32 v[164:165], v[66:67], v[164:165]
    s_waitcnt vmcnt(3)
    v_lshlrev_b32 v68, 16, v20
    v_and_b32 v69, 0xffff0000, v20
    v_pk_fma_f32 v[166:167], v[68:69], v[68:69], v[166:167]
    v_pk_add_f32 v[164:165], v[68:69], v[164:165]
    v_lshlrev_b32 v70, 16, v21
    v_and_b32 v71, 0xffff0000, v21
    v_pk_fma_f32 v[166:167], v[70:71], v[70:71], v[166:167]
    v_pk_add_f32 v[164:165], v[70:71], v[164:165]
    v_lshlrev_b32 v72, 16, v22
    v_and_b32 v73, 0xffff0000, v22
    v_pk_fma_f32 v[166:167], v[72:73], v[72:73], v[166:167]
    v_pk_add_f32 v[164:165], v[72:73], v[164:165]
    v_lshlrev_b32 v74, 16, v23
    v_and_b32 v75, 0xffff0000, v23
    v_pk_fma_f32 v[166:167], v[74:75], v[74:75], v[166:167]
    v_pk_add_f32 v[164:165], v[74:75], v[164:165]
    s_waitcnt vmcnt(2)
    v_lshlrev_b32 v76, 16, v24
    v_and_b32 v77, 0xffff0000, v24
    v_pk_fma_f32 v[166:167], v[76:77], v[76:77], v[166:167]
    v_pk_add_f32 v[164:165], v[76:77], v[164:165]
    v_lshlrev_b32 v78, 16, v25
    v_and_b32 v79, 0xffff0000, v25
    v_pk_fma_f32 v[166:167], v[78:79], v[78:79], v[166:167]
    v_pk_add_f32 v[164:165], v[78:79], v[164:165]
    v_lshlrev_b32 v80, 16, v26
    v_and_b32 v81, 0xffff0000, v26
    v_pk_fma_f32 v[166:167], v[80:81], v[80:81], v[166:167]
    v_pk_add_f32 v[164:165], v[80:81], v[164:165]
    v_lshlrev_b32 v82, 16, v27
    v_and_b32 v83, 0xffff0000, v27
    v_pk_fma_f32 v[166:167], v[82:83], v[82:83], v[166:167]
    v_pk_add_f32 v[164:165], v[82:83], v[164:165]
    s_waitcnt vmcnt(1)
    v_lshlrev_b32 v84, 16, v28
    v_and_b32 v85, 0xffff0000, v28
    v_pk_fma_f32 v[166:167], v[84:85], v[84:85], v[166:167]
    v_pk_add_f32 v[164:165], v[84:85], v[164:165]
    v_lshlrev_b32 v86, 16, v29
    v_and_b32 v87, 0xffff0000, v29
    v_pk_fma_f32 v[166:167], v[86:87], v[86:87], v[166:167]
    v_pk_add_f32 v[164:165], v[86:87], v[164:165]
    v_lshlrev_b32 v88, 16, v30
    v_and_b32 v89, 0xffff0000, v30
    v_pk_fma_f32 v[166:167], v[88:89], v[88:89], v[166:167]
    v_pk_add_f32 v[164:165], v[88:89], v[164:165]
    v_lshlrev_b32 v90, 16, v31
    v_and_b32 v91, 0xffff0000, v31
    v_pk_fma_f32 v[166:167], v[90:91], v[90:91], v[166:167]
    v_pk_add_f32 v[164:165], v[90:91], v[164:165]
    s_waitcnt vmcnt(0)
    v_lshlrev_b32 v92, 16, v32
    v_and_b32 v93, 0xffff0000, v32
    v_pk_fma_f32 v[166:167], v[92:93], v[92:93], v[166:167]
    v_pk_add_f32 v[164:165], v[92:93], v[164:165]
    v_lshlrev_b32 v94, 16, v33
    v_and_b32 v95, 0xffff0000, v33
    v_pk_fma_f32 v[166:167], v[94:95], v[94:95], v[166:167]
    v_pk_add_f32 v[164:165], v[94:95], v[164:165]
    v_lshlrev_b32 v96, 16, v34
    v_and_b32 v97, 0xffff0000, v34
    v_pk_fma_f32 v[166:167], v[96:97], v[96:97], v[166:167]
    v_pk_add_f32 v[164:165], v[96:97], v[164:165]
    v_lshlrev_b32 v98, 16, v35
    v_and_b32 v99, 0xffff0000, v35
    v_pk_fma_f32 v[166:167], v[98:99], v[98:99], v[166:167]
    v_pk_add_f32 v[164:165], v[98:99], v[164:165]
    v_add_f32 v164, v164, v165
    v_add_f32 v166, v166, v167
    s_nop 0
    v_add_f32_dpp v164, v164, v164 quad_perm:[1,0,3,2] row_mask:0xf bank_mask:0xf
    v_add_f32_dpp v166, v166, v166 quad_perm:[1,0,3,2] row_mask:0xf bank_mask:0xf
    s_nop 0
    v_add_f32_dpp v164, v164, v164 quad_perm:[2,3,0,1] row_mask:0xf bank_mask:0xf
    v_add_f32_dpp v166, v166, v166 quad_perm:[2,3,0,1] row_mask:0xf bank_mask:0xf
    s_nop 0
    v_add_f32_dpp v164, v164, v164 row_half_mirror row_mask:0xf bank_mask:0xf
    v_add_f32_dpp v166, v166, v166 row_half_mirror row_mask:0xf bank_mask:0xf
    v_mul_f32 v164, 0x3b000000, v164
    v_mul_f32 v165, v164, v164
    v_mul_f32 v166, 0x3b000000, v166
    v_sub_f32 v166, v166, v165
    v_max_f32 v166, 0, v166
    v_cvt_pk_bf16_f32 v165, v164, v166
    v_lshlrev_b32 v164, 16, v165
    v_and_b32 v166, 0xffff0000, v165
    v_add_f32 v166, 0x3727c5ac, v166
    v_cvt_pk_bf16_f32 v166, v166, v166
    v_lshlrev_b32 v166, 16, v166
    v_sqrt_f32 v166, v166
    s_nop 0
    v_cvt_pk_bf16_f32 v166, v166, v166
    v_lshlrev_b32 v166, 16, v166
    v_rcp_f32 v166, v166
    s_nop 0
    v_mul_f32 v164, v164, v166
    v_pk_fma_f32 v[36:37], v[36:37], v[166:167], v[164:165] op_sel_hi:[1,0,0] neg_lo:[0,0,1] neg_hi:[0,0,1]
    v_cvt_pk_bf16_f32 v4, v36, v37
    v_pk_fma_f32 v[38:39], v[38:39], v[166:167], v[164:165] op_sel_hi:[1,0,0] neg_lo:[0,0,1] neg_hi:[0,0,1]
    v_cvt_pk_bf16_f32 v5, v38, v39
    v_pk_fma_f32 v[40:41], v[40:41], v[166:167], v[164:165] op_sel_hi:[1,0,0] neg_lo:[0,0,1] neg_hi:[0,0,1]
    v_cvt_pk_bf16_f32 v6, v40, v41
    v_pk_fma_f32 v[42:43], v[42:43], v[166:167], v[164:165] op_sel_hi:[1,0,0] neg_lo:[0,0,1] neg_hi:[0,0,1]
    v_cvt_pk_bf16_f32 v7, v42, v43
    ds_write_b128 v3, v[4:7] offset:0
    v_pk_fma_f32 v[44:45], v[44:45], v[166:167], v[164:165] op_sel_hi:[1,0,0] neg_lo:[0,0,1] neg_hi:[0,0,1]
    v_cvt_pk_bf16_f32 v8, v44, v45
    v_pk_fma_f32 v[46:47], v[46:47], v[166:167], v[164:165] op_sel_hi:[1,0,0] neg_lo:[0,0,1] neg_hi:[0,0,1]
    v_cvt_pk_bf16_f32 v9, v46, v47
    v_pk_fma_f32 v[48:49], v[48:49], v[166:167], v[164:165] op_sel_hi:[1,0,0] neg_lo:[0,0,1] neg_hi:[0,0,1]
    v_cvt_pk_bf16_f32 v10, v48, v49
    v_pk_fma_f32 v[50:51], v[50:51], v[166:167], v[164:165] op_sel_hi:[1,0,0] neg_lo:[0,0,1] neg_hi:[0,0,1]
    v_cvt_pk_bf16_f32 v11, v50, v51
    ds_write_b128 v3, v[8:11] offset:128
    v_pk_fma_f32 v[52:53], v[52:53], v[166:167], v[164:165] op_sel_hi:[1,0,0] neg_lo:[0,0,1] neg_hi:[0,0,1]
    v_cvt_pk_bf16_f32 v12, v52, v53
    v_pk_fma_f32 v[54:55], v[54:55], v[166:167], v[164:165] op_sel_hi:[1,0,0] neg_lo:[0,0,1] neg_hi:[0,0,1]
    v_cvt_pk_bf16_f32 v13, v54, v55
    v_pk_fma_f32 v[56:57], v[56:57], v[166:167], v[164:165] op_sel_hi:[1,0,0] neg_lo:[0,0,1] neg_hi:[0,0,1]
    v_cvt_pk_bf16_f32 v14, v56, v57
    v_pk_fma_f32 v[58:59], v[58:59], v[166:167], v[164:165] op_sel_hi:[1,0,0] neg_lo:[0,0,1] neg_hi:[0,0,1]
    v_cvt_pk_bf16_f32 v15, v58, v59
    ds_write_b128 v3, v[12:15] offset:256
    v_pk_fma_f32 v[60:61], v[60:61], v[166:167], v[164:165] op_sel_hi:[1,0,0] neg_lo:[0,0,1] neg_hi:[0,0,1]
    v_cvt_pk_bf16_f32 v16, v60, v61
    v_pk_fma_f32 v[62:63], v[62:63], v[166:167], v[164:165] op_sel_hi:[1,0,0] neg_lo:[0,0,1] neg_hi:[0,0,1]
    v_cvt_pk_bf16_f32 v17, v62, v63
    v_pk_fma_f32 v[64:65], v[64:65], v[166:167], v[164:165] op_sel_hi:[1,0,0] neg_lo:[0,0,1] neg_hi:[0,0,1]
    v_cvt_pk_bf16_f32 v18, v64, v65
    v_pk_fma_f32 v[66:67], v[66:67], v[166:167], v[164:165] op_sel_hi:[1,0,0] neg_lo:[0,0,1] neg_hi:[0,0,1]
    v_cvt_pk_bf16_f32 v19, v66, v67
    ds_write_b128 v3, v[16:19] offset:384
    v_pk_fma_f32 v[68:69], v[68:69], v[166:167], v[164:165] op_sel_hi:[1,0,0] neg_lo:[0,0,1] neg_hi:[0,0,1]
    v_cvt_pk_bf16_f32 v20, v68, v69
    v_pk_fma_f32 v[70:71], v[70:71], v[166:167], v[164:165] op_sel_hi:[1,0,0] neg_lo:[0,0,1] neg_hi:[0,0,1]
    v_cvt_pk_bf16_f32 v21, v70, v71
    v_pk_fma_f32 v[72:73], v[72:73], v[166:167], v[164:165] op_sel_hi:[1,0,0] neg_lo:[0,0,1] neg_hi:[0,0,1]
    v_cvt_pk_bf16_f32 v22, v72, v73
    v_pk_fma_f32 v[74:75], v[74:75], v[166:167], v[164:165] op_sel_hi:[1,0,0] neg_lo:[0,0,1] neg_hi:[0,0,1]
    v_cvt_pk_bf16_f32 v23, v74, v75
    ds_write_b128 v3, v[20:23] offset:512
    v_pk_fma_f32 v[76:77], v[76:77], v[166:167], v[164:165] op_sel_hi:[1,0,0] neg_lo:[0,0,1] neg_hi:[0,0,1]
    v_cvt_pk_bf16_f32 v24, v76, v77
    v_pk_fma_f32 v[78:79], v[78:79], v[166:167], v[164:165] op_sel_hi:[1,0,0] neg_lo:[0,0,1] neg_hi:[0,0,1]
    v_cvt_pk_bf16_f32 v25, v78, v79
    v_pk_fma_f32 v[80:81], v[80:81], v[166:167], v[164:165] op_sel_hi:[1,0,0] neg_lo:[0,0,1] neg_hi:[0,0,1]
    v_cvt_pk_bf16_f32 v26, v80, v81
    v_pk_fma_f32 v[82:83], v[82:83], v[166:167], v[164:165] op_sel_hi:[1,0,0] neg_lo:[0,0,1] neg_hi:[0,0,1]
    v_cvt_pk_bf16_f32 v27, v82, v83
    ds_write_b128 v3, v[24:27] offset:640
    v_pk_fma_f32 v[84:85], v[84:85], v[166:167], v[164:165] op_sel_hi:[1,0,0] neg_lo:[0,0,1] neg_hi:[0,0,1]
    v_cvt_pk_bf16_f32 v28, v84, v85
    v_pk_fma_f32 v[86:87], v[86:87], v[166:167], v[164:165] op_sel_hi:[1,0,0] neg_lo:[0,0,1] neg_hi:[0,0,1]
    v_cvt_pk_bf16_f32 v29, v86, v87
    v_pk_fma_f32 v[88:89], v[88:89], v[166:167], v[164:165] op_sel_hi:[1,0,0] neg_lo:[0,0,1] neg_hi:[0,0,1]
    v_cvt_pk_bf16_f32 v30, v88, v89
    v_pk_fma_f32 v[90:91], v[90:91], v[166:167], v[164:165] op_sel_hi:[1,0,0] neg_lo:[0,0,1] neg_hi:[0,0,1]
    v_cvt_pk_bf16_f32 v31, v90, v91
    ds_write_b128 v3, v[28:31] offset:768
    v_pk_fma_f32 v[92:93], v[92:93], v[166:167], v[164:165] op_sel_hi:[1,0,0] neg_lo:[0,0,1] neg_hi:[0,0,1]
    v_cvt_pk_bf16_f32 v32, v92, v93
    v_pk_fma_f32 v[94:95], v[94:95], v[166:167], v[164:165] op_sel_hi:[1,0,0] neg_lo:[0,0,1] neg_hi:[0,0,1]
    v_cvt_pk_bf16_f32 v33, v94, v95
    v_pk_fma_f32 v[96:97], v[96:97], v[166:167], v[164:165] op_sel_hi:[1,0,0] neg_lo:[0,0,1] neg_hi:[0,0,1]
    v_cvt_pk_bf16_f32 v34, v96, v97
    v_pk_fma_f32 v[98:99], v[98:99], v[166:167], v[164:165] op_sel_hi:[1,0,0] neg_lo:[0,0,1] neg_hi:[0,0,1]
    v_cvt_pk_bf16_f32 v35, v98, v99
    ds_write_b128 v3, v[32:35] offset:896
    s_waitcnt lgkmcnt(0)
    s_add_u32 s6, s6, 0x9e3779b1
    s_barrier
    s_cmp_lg_u32 s3, 0
    s_cbranch_scc1 L_A_nokv
    s_setprio 3
    v_lshrrev_b32 v2, 4, v0
    v_and_b32 v164, 15, v0
    v_lshlrev_b32 v3, 3, v164
    v_lshl_add_u32 v3, v2, 12, v3
    v_add_u32 v3, 140288, v3
    s_and_b32 s13, s5, 3
    s_mul_i32 s13, s13, 16640
    v_mul_u32_u24 v165, 1040, v164
    v_lshl_add_u32 v165, v2, 8, v165
    v_add_u32 v165, s13, v165
    ds_read_b128 v[36:39], v165 offset:0
    ds_read_b64_tr_b16 v[100:101], v3 offset:0
    ds_read_b64_tr_b16 v[102:103], v3 offset:128
    ds_read_b128 v[40:43], v165 offset:16
    ds_read_b64_tr_b16 v[104:105], v3 offset:256
    ds_read_b64_tr_b16 v[106:107], v3 offset:384
    ds_read_b128 v[44:47], v165 offset:32
    ds_read_b64_tr_b16 v[108:109], v3 offset:512
    ds_read_b64_tr_b16 v[110:111], v3 offset:640
    ds_read_b128 v[48:51], v165 offset:48
    ds_read_b64_tr_b16 v[112:113], v3 offset:768
    ds_read_b64_tr_b16 v[114:115], v3 offset:896
    v_and_b32 v166, 1, v2
    v_lshrrev_b32 v167, 1, v2
    v_lshlrev_b32 v167, 3, v167
    v_lshl_add_u32 v167, v164, 4, v167
    s_bfe_u32 s13, s5, 0x10001
    s_lshl_b32 s14, s4, 1
    s_add_u32 s13, s13, s14
    s_lshl_b32 s13, s13, 11
    s_add_u32 s13, s13, 262144
    s_and_b32 s14, s5, 1
    s_cmp_ge_u32 s5, 4
    s_cbranch_scc1 L_A_v
    ds_read_b128 v[52:55], v165 offset:64
    ds_read_b64_tr_b16 v[116:117], v3 offset:1024
    ds_read_b64_tr_b16 v[118:119], v3 offset:1152
    s_waitcnt lgkmcnt(12)
    v_mfma_f32_16x16x32_bf16 v[4:7], v[100:103], v[36:39], 0
    ds_read_b128 v[56:59], v165 offset:80
    ds_read_b64_tr_b16 v[120:121], v3 offset:1280
    ds_read_b64_tr_b16 v[122:123], v3 offset:1408
    s_waitcnt lgkmcnt(12)
    v_mfma_f32_16x16x32_bf16 v[8:11], v[104:107], v[40:43], 0
    ds_read_b128 v[60:63], v165 offset:96
    ds_read_b64_tr_b16 v[124:125], v3 offset:1536
    ds_read_b64_tr_b16 v[126:127], v3 offset:1664
    s_waitcnt lgkmcnt(12)
    v_mfma_f32_16x16x32_bf16 v[4:7], v[108:111], v[44:47], v[4:7]
    ds_read_b128 v[64:67], v165 offset:112
    ds_read_b64_tr_b16 v[128:129], v3 offset:1792
    ds_read_b64_tr_b16 v[130:131], v3 offset:1920
    s_waitcnt lgkmcnt(12)
    v_mfma_f32_16x16x32_bf16 v[8:11], v[112:115], v[48:51], v[8:11]
    ds_read_b128 v[68:71], v165 offset:128
    ds_read_b64_tr_b16 v[132:133], v3 offset:2048
    ds_read_b64_tr_b16 v[134:135], v3 offset:2176
    s_waitcnt lgkmcnt(12)
    v_mfma_f32_16x16x32_bf16 v[4:7], v[116:119], v[52:55], v[4:7]
    ds_read_b128 v[72:75], v165 offset:144
    ds_read_b64_tr_b16 v[136:137], v3 offset:2304
    ds_read_b64_tr_b16 v[138:139], v3 offset:2432
    s_waitcnt lgkmcnt(12)
    v_mfma_f32_16x16x32_bf16 v[8:11], v[120:123], v[56:59], v[8:11]
    ds_read_b128 v[76:79], v165 offset:160
    ds_read_b64_tr_b16 v[140:141], v3 offset:2560
    ds_read_b64_tr_b16 v[142:143], v3 offset:2688
    s_waitcnt lgkmcnt(12)
    v_mfma_f32_16x16x32_bf16 v[4:7], v[124:127], v[60:63], v[4:7]
    ds_read_b128 v[80:83], v165 offset:176
    ds_read_b64_tr_b16 v[144:145], v3 offset:2816
    ds_read_b64_tr_b16 v[146:147], v3 offset:2944
    s_waitcnt lgkmcnt(12)
    v_mfma_f32_16x16x32_bf16 v[8:11], v[128:131], v[64:67], v[8:11]
    ds_read_b128 v[84:87], v165 offset:192
    ds_read_b64_tr_b16 v[148:149], v3 offset:3072
    ds_read_b64_tr_b16 v[150:151], v3 offset:3200
    s_waitcnt lgkmcnt(12)
    v_mfma_f32_16x16x32_bf16 v[4:7], v[132:135], v[68:71], v[4:7]
    ds_read_b128 v[88:91], v165 offset:208
    ds_read_b64_tr_b16 v[152:153], v3 offset:3328
    ds_read_b64_tr_b16 v[154:155], v3 offset:3456
    s_waitcnt lgkmcnt(12)
    v_mfma_f32_16x16x32_bf16 v[8:11], v[136:139], v[72:75], v[8:11]
    ds_read_b128 v[92:95], v165 offset:224
    ds_read_b64_tr_b16 v[156:157], v3 offset:3584
    ds_read_b64_tr_b16 v[158:159], v3 offset:3712
    s_waitcnt lgkmcnt(12)
    v_mfma_f32_16x16x32_bf16 v[4:7], v[140:143], v[76:79], v[4:7]
    ds_read_b128 v[96:99], v165 offset:240
    ds_read_b64_tr_b16 v[160:161], v3 offset:3840
    ds_read_b64_tr_b16 v[162:163], v3 offset:3968
    s_waitcnt lgkmcnt(12)
    v_mfma_f32_16x16x32_bf16 v[8:11], v[144:147], v[80:83], v[8:11]
    s_waitcnt lgkmcnt(9)
    v_mfma_f32_16x16x32_bf16 v[4:7], v[148:151], v[84:87], v[4:7]
    s_waitcnt lgkmcnt(6)
    v_mfma_f32_16x16x32_bf16 v[8:11], v[152:155], v[88:91], v[8:11]
    s_waitcnt lgkmcnt(3)
    v_mfma_f32_16x16x32_bf16 v[4:7], v[156:159], v[92:95], v[4:7]
    s_waitcnt lgkmcnt(0)
    v_mfma_f32_16x16x32_bf16 v[8:11], v[160:163], v[96:99], v[8:11]
    v_lshl_add_u32 v167, v166, 9, v167
    s_lshl_b32 s14, s14, 8
    v_mov_b32 v164, 0x3eb8aa3b
    s_branch L_A_kvst
L_A_v:
    ds_read_b128 v[52:55], v165 offset:64
    ds_read_b64_tr_b16 v[116:117], v3 offset:1024
    ds_read_b64_tr_b16 v[118:119], v3 offset:1152
    s_waitcnt lgkmcnt(12)
    v_mfma_f32_16x16x32_bf16 v[4:7], v[36:39], v[100:103], 0
    ds_read_b128 v[56:59], v165 offset:80
    ds_read_b64_tr_b16 v[120:121], v3 offset:1280
    ds_read_b64_tr_b16 v[122:123], v3 offset:1408
    s_waitcnt lgkmcnt(12)
    v_mfma_f32_16x16x32_bf16 v[8:11], v[40:43], v[104:107], 0
    ds_read_b128 v[60:63], v165 offset:96
    ds_read_b64_tr_b16 v[124:125], v3 offset:1536
    ds_read_b64_tr_b16 v[126:127], v3 offset:1664
    s_waitcnt lgkmcnt(12)
    v_mfma_f32_16x16x32_bf16 v[4:7], v[44:47], v[108:111], v[4:7]
    ds_read_b128 v[64:67], v165 offset:112
    ds_read_b64_tr_b16 v[128:129], v3 offset:1792
    ds_read_b64_tr_b16 v[130:131], v3 offset:1920
    s_waitcnt lgkmcnt(12)
    v_mfma_f32_16x16x32_bf16 v[8:11], v[48:51], v[112:115], v[8:11]
    ds_read_b128 v[68:71], v165 offset:128
    ds_read_b64_tr_b16 v[132:133], v3 offset:2048
    ds_read_b64_tr_b16 v[134:135], v3 offset:2176
    s_waitcnt lgkmcnt(12)
    v_mfma_f32_16x16x32_bf16 v[4:7], v[52:55], v[116:119], v[4:7]
    ds_read_b128 v[72:75], v165 offset:144
    ds_read_b64_tr_b16 v[136:137], v3 offset:2304
    ds_read_b64_tr_b16 v[138:139], v3 offset:2432
    s_waitcnt lgkmcnt(12)
    v_mfma_f32_16x16x32_bf16 v[8:11], v[56:59], v[120:123], v[8:11]
    ds_read_b128 v[76:79], v165 offset:160
    ds_read_b64_tr_b16 v[140:141], v3 offset:2560
    ds_read_b64_tr_b16 v[142:143], v3 offset:2688
    s_waitcnt lgkmcnt(12)
    v_mfma_f32_16x16x32_bf16 v[4:7], v[60:63], v[124:127], v[4:7]
    ds_read_b128 v[80:83], v165 offset:176
    ds_read_b64_tr_b16 v[144:145], v3 offset:2816
    ds_read_b64_tr_b16 v[146:147], v3 offset:2944
    s_waitcnt lgkmcnt(12)
    v_mfma_f32_16x16x32_bf16 v[8:11], v[64:67], v[128:131], v[8:11]
    ds_read_b128 v[84:87], v165 offset:192
    ds_read_b64_tr_b16 v[148:149], v3 offset:3072
    ds_read_b64_tr_b16 v[150:151], v3 offset:3200
    s_waitcnt lgkmcnt(12)
    v_mfma_f32_16x16x32_bf16 v[4:7], v[68:71], v[132:135], v[4:7]
    ds_read_b128 v[88:91], v165 offset:208
    ds_read_b64_tr_b16 v[152:153], v3 offset:3328
    ds_read_b64_tr_b16 v[154:155], v3 offset:3456
    s_waitcnt lgkmcnt(12)
    v_mfma_f32_16x16x32_bf16 v[8:11], v[72:75], v[136:139], v[8:11]
    ds_read_b128 v[92:95], v165 offset:224
    ds_read_b64_tr_b16 v[156:157], v3 offset:3584
    ds_read_b64_tr_b16 v[158:159], v3 offset:3712
    s_waitcnt lgkmcnt(12)
    v_mfma_f32_16x16x32_bf16 v[4:7], v[76:79], v[140:143], v[4:7]
    ds_read_b128 v[96:99], v165 offset:240
    ds_read_b64_tr_b16 v[160:161], v3 offset:3840
    ds_read_b64_tr_b16 v[162:163], v3 offset:3968
    s_waitcnt lgkmcnt(12)
    v_mfma_f32_16x16x32_bf16 v[8:11], v[80:83], v[144:147], v[8:11]
    s_waitcnt lgkmcnt(9)
    v_mfma_f32_16x16x32_bf16 v[4:7], v[84:87], v[148:151], v[4:7]
    s_waitcnt lgkmcnt(6)
    v_mfma_f32_16x16x32_bf16 v[8:11], v[88:91], v[152:155], v[8:11]
    s_waitcnt lgkmcnt(3)
    v_mfma_f32_16x16x32_bf16 v[4:7], v[92:95], v[156:159], v[4:7]
    s_waitcnt lgkmcnt(0)
    v_mfma_f32_16x16x32_bf16 v[8:11], v[96:99], v[160:163], v[8:11]
    v_lshlrev_b32 v167, 4, v164
    v_lshl_add_u32 v167, v166, 3, v167
    v_lshrrev_b32 v166, 1, v2
    v_lshl_add_u32 v167, v166, 8, v167
    s_lshl_b32 s14, s14, 9
    s_add_u32 s14, s14, 1024
    v_mov_b32 v164, 1.0
L_A_kvst:
    s_add_u32 s13, s13, s14
    s_nop 5
    v_pk_add_f32 v[4:5], v[4:5], v[8:9]
    v_pk_add_f32 v[6:7], v[6:7], v[10:11]
    v_pk_mul_f32 v[4:5], v[4:5], v[164:165] op_sel_hi:[1,0]
    v_pk_mul_f32 v[6:7], v[6:7], v[164:165] op_sel_hi:[1,0]
    v_cvt_pk_bf16_f32 v4, v4, v5
    v_cvt_pk_bf16_f32 v5, v6, v7
    buffer_store_dwordx2 v[4:5], v167, s[8:11], s13 offen sc1
    s_lshl_b32 s13, s4, 3
    s_add_u32 s13, s13, s5
    s_and_b32 s14, s13, 7
    s_lshl_b32 s14, s14, 2
    s_lshr_b32 s13, s13, 3
    s_lshl_b32 s13, s13, 7
    s_add_u32 s13, s13, s14
    s_add_u32 s13, s13, 4096
    v_mov_b32 v166, s6
    v_mov_b32 v167, 0
    s_waitcnt vmcnt(0)
    s_mov_b64 exec, 1
    buffer_store_dword v166, v167, s[8:11], s13 offen sc1
    s_mov_b64 exec, -1
    s_setprio 0
L_A_nokv:
    v_and_b32 v44, 15, v0
    v_lshrrev_b32 v45, 5, v0
    v_lshl_add_u32 v2, v45, 4, v44
    v_lshlrev_b32 v2, 4, v2
    s_mov_b32 s62, 0xffff
    s_mov_b32 s63, 0xffff
    v_and_b32 v44, 27, v0
    v_cmp_eq_u32 vcc, 16, v44
    v_mov_b32 v45, 0x3f803f80
    v_mov_b32 v44, 0
    v_cndmask_b32 v44, v44, v45, vcc
    v_mov_b32 v24, v44
    v_mov_b32 v25, v44
    v_mov_b32 v26, v44
    v_mov_b32 v27, v44
    v_mov_b32 v28, v44
    v_mov_b32 v29, v44
    v_mov_b32 v30, v44
    v_mov_b32 v31, v44
    v_mov_b32 v36, v44
    v_mov_b32 v37, v44
    v_mov_b32 v38, v44
    v_mov_b32 v39, v44
    v_mov_b32 v40, v44
    v_mov_b32 v41, v44
    v_mov_b32 v42, v44
    v_mov_b32 v43, v44
    v_mov_b32 v76, v44
    v_mov_b32 v77, v44
    v_mov_b32 v78, v44
    v_mov_b32 v79, v44
    v_mov_b32 v80, v44
    v_mov_b32 v81, v44
    v_mov_b32 v82, v44
    v_mov_b32 v83, v44
    v_mov_b32 v84, 0
    v_mov_b32 v85, 0
    v_mov_b32 v86, 0
    v_mov_b32 v87, 0
    v_mov_b32 v88, 0
    v_mov_b32 v89, 0
    v_mov_b32 v90, 0
    v_mov_b32 v91, 0
    v_mov_b32 v92, 0
    v_mov_b32 v93, 0
    v_mov_b32 v94, 0
    v_mov_b32 v95, 0
    v_mov_b32 v96, 0
    v_mov_b32 v97, 0
    v_mov_b32 v98, 0
    v_mov_b32 v99, 0
    v_mov_b32 v100, 0
    v_mov_b32 v101, 0
    v_mov_b32 v102, 0
    v_mov_b32 v103, 0
    v_mov_b32 v104, 0
    v_mov_b32 v105, 0
    v_mov_b32 v106, 0
    v_mov_b32 v107, 0
    v_mov_b32 v108, 0
    v_mov_b32 v109, 0
    v_mov_b32 v110, 0
    v_mov_b32 v111, 0
    v_mov_b32 v112, 0
    v_mov_b32 v113, 0
    v_mov_b32 v114, 0
    v_mov_b32 v115, 0
    v_mov_b32 v116, 0
    v_mov_b32 v117, 0
    v_mov_b32 v118, 0
    v_mov_b32 v119, 0
    v_mov_b32 v120, 0
    v_mov_b32 v121, 0
    v_mov_b32 v122, 0
    v_mov_b32 v123, 0
    v_mov_b32 v124, 0
    v_mov_b32 v125, 0
    v_mov_b32 v126, 0
    v_mov_b32 v127, 0
    v_mov_b32 v128, 0
    v_mov_b32 v129, 0
    v_mov_b32 v130, 0
    v_mov_b32 v131, 0
    v_mov_b32 v132, 0
    v_mov_b32 v133, 0
    v_mov_b32 v134, 0
    v_mov_b32 v135, 0
    v_mov_b32 v136, 0
    v_mov_b32 v137, 0
    v_mov_b32 v138, 0
    v_mov_b32 v139, 0
    v_mov_b32 v140, 0
    v_mov_b32 v141, 0
    v_mov_b32 v142, 0
    v_mov_b32 v143, 0
    v_mov_b32 v144, 0
    v_mov_b32 v145, 0
    v_mov_b32 v146, 0
    v_mov_b32 v147, 0
    v_mov_b32 v3, 0xdddddddd
    s_and_b32 s92, s3, 3
    s_lshl_b32 s90, s92, 15
    s_add_u32 s90, s90, 262144
    s_add_u32 s91, s90, 32768
    s_bfe_u32 s56, s2, 0x40003
    s_lshl_b32 s56, s56, 11
    s_add_u32 s56, s56, s90
    s_and_b32 s14, s3, 4
    s_add_u32 s93, s14, 12
    v_mov_b32 v153, 159744
    v_mov_b32 v154, 1
    v_add_u32 v155, s14, v153
    v_lshlrev_b32 v46, 2, v0
    s_lshl_b32 s15, s14, 10
    s_add_u32 s14, s15, 132096
    s_add_u32 s12, s92, 1
    s_and_b32 s12, s12, 3
    s_lshl_b32 s13, s12, 10
    s_add_u32 s13, s13, s14
    v_add_u32 v60, s13, v1
    s_mul_i32 s12, s12, 6912
    s_add_u32 s12, s12, 132096
    v_add_u32 v156, s12, v1
    v_add_u32 v157, s12, v46
    s_add_u32 s12, s92, 2
    s_and_b32 s12, s12, 3
    s_lshl_b32 s13, s12, 10
    s_add_u32 s13, s13, s14
    v_add_u32 v61, s13, v1
    s_mul_i32 s12, s12, 6912
    s_add_u32 s12, s12, 134400
    v_add_u32 v158, s12, v1
    v_add_u32 v159, s12, v46
    s_add_u32 s12, s92, 3
    s_and_b32 s12, s12, 3
    s_lshl_b32 s13, s12, 10
    s_add_u32 s13, s13, s14
    v_add_u32 v62, s13, v1
    s_mul_i32 s12, s12, 6912
    s_add_u32 s12, s12, 136704
    v_add_u32 v160, s12, v1
    v_add_u32 v161, s12, v46
    s_add_u32 s12, s92, 4
    s_and_b32 s12, s12, 3
    s_lshl_b32 s13, s12, 10
    s_add_u32 s13, s13, s14
    v_add_u32 v63, s13, v1
    s_mul_i32 s12, s12, 6912
    s_add_u32 s12, s12, 132096
    v_add_u32 v162, s12, v1
    v_add_u32 v163, s12, v46
    v_and_b32 v44, 15, v0
    v_lshrrev_b32 v45, 4, v0
    v_lshlrev_b32 v165, 10, v44
    v_lshl_add_u32 v165, v45, 4, v165
    v_bfe_u32 v47, v0, 3, 1
    v_mul_u32_u24 v47, 8128, v47
    v_sub_u32 v165, v165, v47
    v_lshrrev_b32 v164, 5, v0
    v_lshlrev_b32 v164, 11, v164
    v_bfe_u32 v47, v0, 4, 1
    v_lshl_add_u32 v164, v47, 9, v164
    v_lshl_add_u32 v164, v44, 4, v164
    s_lshl_b32 s12, s92, 12
    s_add_u32 s12, s12, 66560
    v_add_u32 v167, s12, v1
    v_bfe_u32 v47, v0, 2, 3
    v_lshrrev_b32 v166, 5, v0
    v_lshl_add_u32 v166, v166, 4, v47
    v_lshlrev_b32 v166, 7, v166
    v_lshrrev_b32 v47, 1, v47
    v_lshl_add_u32 v166, v47, 5, v166
    v_and_b32 v47, 3, v0
    v_lshl_add_u32 v166, v47, 3, v166
    s_and_b32 s12, s5, 4
    s_xor_b32 s12, s12, 4
    s_lshl_b32 s12, s12, 13
    s_add_u32 s15, s15, s12
    v_add_u32 v166, s15, v166
    s_lshl_b32 s12, s4, 16
    s_lshl_b32 s13, s92, 14
    s_add_u32 s13, s12, s13
    s_lshl_b32 s14, s5, 7
    s_add_u32 s57, s13, s14
    s_lshr_b32 s13, s92, 1
    s_lshl_b32 s13, s13, 10
    s_add_u32 s12, s12, s13
    s_add_u32 s12, s12, s15
    s_and_b32 s13, s92, 1
    s_lshl_b32 s13, s13, 8
    s_add_u32 s12, s12, s13
    s_add_u32 s94, s12, 1048576
    s_xor_b32 s95, s94, 0x8000
    s_mov_b32 s48, s36
    s_mov_b32 s49, s37
    s_mov_b32 s50, 2097152
    s_mov_b32 s51, 0x20000
    v_lshrrev_b32 v44, 3, v0
    v_lshlrev_b32 v44, 7, v44
    v_and_b32 v45, 7, v0
    v_lshl_add_u32 v44, v45, 2, v44
    s_lshl_b32 s13, s92, 10
    s_add_u32 s13, s13, 4096
    s_lshr_b32 s14, s3, 2
    s_add_u32 s14, s14, 1
    s_barrier
    s_mov_b32 s61, 200000
L_pkv:
    buffer_load_dword v152, v44, s[8:11], s13 offen sc1
    s_waitcnt vmcnt(0)
    v_cmp_eq_u32 vcc, s6, v152
    s_nop 1
    s_cmp_eq_u64 vcc, -1
    s_cbranch_scc1 L_pkv_ok
    s_sleep 2
    s_sub_u32 s61, s61, 1
    s_cmp_lg_u32 s61, 0
    s_cbranch_scc1 L_pkv
L_pkv_ok:
    buffer_load_dwordx4 v[20:23], v1, s[8:11], s56 offen sc1
    s_mov_b64 exec, s[62:63]
    buffer_load_dwordx4 v[24:27], v2, s[8:11], s56 offen offset:1024 sc1
    buffer_load_dwordx4 v[28:31], v2, s[8:11], s56 offen offset:1536 sc1
    s_mov_b64 exec, -1
    s_add_u32 s56, s56, 2048
    s_cmp_eq_u32 s56, s91
    s_cselect_b32 s56, s90, s56
    buffer_load_dwordx4 v[32:35], v1, s[8:11], s56 offen sc1
    s_mov_b64 exec, s[62:63]
    buffer_load_dwordx4 v[36:39], v2, s[8:11], s56 offen offset:1024 sc1
    buffer_load_dwordx4 v[40:43], v2, s[8:11], s56 offen offset:1536 sc1
    s_mov_b64 exec, -1
    s_add_u32 s56, s56, 2048
    s_cmp_eq_u32 s56, s91
    s_cselect_b32 s56, s90, s56
    buffer_load_dwordx4 v[148:151], v1, s[8:11], s56 offen sc1
    s_mov_b64 exec, s[62:63]
    buffer_load_dwordx4 v[76:79], v2, s[8:11], s56 offen offset:1024 sc1
    buffer_load_dwordx4 v[80:83], v2, s[8:11], s56 offen offset:1536 sc1
    s_mov_b64 exec, -1
    s_add_u32 s56, s56, 2048
    s_cmp_eq_u32 s56, s91
    s_cselect_b32 s56, s90, s56
    s_lshl_b32 s52, s92, 12
    s_add_u32 s52, s52, 140288
    s_lshl_b32 s53, s92, 14
    s_add_u32 s53, s53, 66560
    s_mul_i32 s44, s92, 6144
    s_add_u32 s44, s44, 132096
    s_lshl_b32 s54, s92, 3
    s_add_u32 s54, s54, 159744
    s_bfe_u32 s45, s2, 0x40003
    s_cmp_ge_u32 s3, 4
    s_cselect_b64 vcc, -1, 0
    v_mov_b32 v0, s54
    s_cbranch_vccz L_npl
    s_add_u32 m0, s52, 0
    s_add_u32 s12, s45, 3
    s_and_b32 s12, s12, 15
    s_lshl_b32 s12, s12, 11
    s_add_u32 s12, s12, s90
    buffer_load_dwordx4 v1, s[8:11], s12 offen sc1 lds
    buffer_load_dwordx4 v1, s[8:11], s12 offen offset:1024 sc1 lds
    s_add_u32 m0, s52, 2048
    s_add_u32 s12, s45, 4
    s_and_b32 s12, s12, 15
    s_lshl_b32 s12, s12, 11
    s_add_u32 s12, s12, s90
    buffer_load_dwordx4 v1, s[8:11], s12 offen sc1 lds
    buffer_load_dwordx4 v1, s[8:11], s12 offen offset:1024 sc1 lds
L_npl:
    s_mov_b64 exec, 1
    ds_add_u32 v153, v154 offset:24
    s_mov_b64 exec, -1
    s_cbranch_vccz L_nps
    s_waitcnt vmcnt(0)
    s_mov_b64 exec, 1
    ds_add_u32 v0, v154 offset:96
    s_mov_b64 exec, -1
L_nps:
    s_mov_b32 s61, 800000
L_pqs:
    ds_read_b32 v152, v153 offset:80
    s_waitcnt lgkmcnt(0)
    v_readfirstlane_b32 s12, v152
    s_nop 1
    s_cmp_eq_u32 s12, 1
    s_cbranch_scc1 L_pqs_ok
    s_sleep 1
    s_sub_u32 s61, s61, 1
    s_cmp_lg_u32 s61, 0
    s_cbranch_scc1 L_pqs
L_pqs_ok:
    s_mov_b32 s61, 800000
L_pq:
    ds_read_b32 v152, v153 offset:0
    ds_read_b128 v[4:7], v60 offset:0
    ds_read_b128 v[8:11], v61 offset:0
    ds_read_b128 v[12:15], v62 offset:0
    ds_read_b128 v[16:19], v63 offset:0
    s_waitcnt lgkmcnt(4)
    v_readfirstlane_b32 s12, v152
    s_sub_u32 s61, s61, 1
    s_cbranch_scc1 L_pq_ok
    s_cmp_lt_u32 s12, s14
    s_cbranch_scc1 L_pq
L_pq_ok:
    s_waitcnt vmcnt(8) lgkmcnt(0)
    s_setprio 2
    v_mfma_f32_32x32x16_bf16 v[44:59], v[20:23], v[4:7], 0
    s_nop 11
    v_exp_f32 v44, v44
    v_exp_f32 v45, v45
    v_exp_f32 v46, v46
    v_exp_f32 v47, v47
    v_exp_f32 v48, v48
    v_mfma_f32_32x32x16_bf16 v[60:75], v[20:23], v[8:11], 0
    s_waitcnt vmcnt(7)
    v_exp_f32 v49, v49
    v_exp_f32 v50, v50
    v_exp_f32 v51, v51
    v_exp_f32 v52, v52
    v_exp_f32 v53, v53
    v_smfmac_f32_32x32x32_bf16 v[84:99], v[24:27], v[44:51], v3
    s_waitcnt vmcnt(6)
    v_exp_f32 v54, v54
    v_exp_f32 v55, v55
    v_exp_f32 v56, v56
    v_exp_f32 v57, v57
    v_exp_f32 v58, v58
    v_exp_f32 v59, v59
    v_exp_f32 v60, v60
    v_exp_f32 v61, v61
    v_smfmac_f32_32x32x32_bf16 v[84:99], v[28:31], v[52:59], v3
    v_exp_f32 v62, v62
    v_exp_f32 v63, v63
    v_exp_f32 v64, v64
    v_mfma_f32_32x32x16_bf16 v[44:59], v[20:23], v[12:15], 0
    v_exp_f32 v65, v65
    v_exp_f32 v66, v66
    v_exp_f32 v67, v67
    v_exp_f32 v68, v68
    v_exp_f32 v69, v69
    v_smfmac_f32_32x32x32_bf16 v[100:115], v[24:27], v[60:67], v3
    v_exp_f32 v70, v70
    v_exp_f32 v71, v71
    v_exp_f32 v72, v72
    v_exp_f32 v73, v73
    v_exp_f32 v74, v74
    v_exp_f32 v75, v75
    v_exp_f32 v44, v44
    v_exp_f32 v45, v45
    v_smfmac_f32_32x32x32_bf16 v[100:115], v[28:31], v[68:75], v3
    v_exp_f32 v46, v46
    v_exp_f32 v47, v47
    v_exp_f32 v48, v48
    v_mfma_f32_32x32x16_bf16 v[60:75], v[20:23], v[16:19], 0
    v_exp_f32 v49, v49
    v_exp_f32 v50, v50
    v_exp_f32 v51, v51
    v_exp_f32 v52, v52
    v_exp_f32 v53, v53
    v_smfmac_f32_32x32x32_bf16 v[116:131], v[24:27], v[44:51], v3
    v_exp_f32 v54, v54
    v_exp_f32 v55, v55
    v_exp_f32 v56, v56
    v_exp_f32 v57, v57
    v_exp_f32 v58, v58
    v_exp_f32 v59, v59
    v_exp_f32 v60, v60
    v_exp_f32 v61, v61
    v_smfmac_f32_32x32x32_bf16 v[116:131], v[28:31], v[52:59], v3
    s_waitcnt vmcnt(5)
    v_exp_f32 v62, v62
    v_exp_f32 v63, v63
    v_exp_f32 v64, v64
    v_mfma_f32_32x32x16_bf16 v[44:59], v[32:35], v[4:7], 0
    v_exp_f32 v65, v65
    v_exp_f32 v66, v66
    v_exp_f32 v67, v67
    v_exp_f32 v68, v68
    v_exp_f32 v69, v69
    v_smfmac_f32_32x32x32_bf16 v[132:147], v[24:27], v[60:67], v3
    v_exp_f32 v70, v70
    v_exp_f32 v71, v71
    v_exp_f32 v72, v72
    v_exp_f32 v73, v73
    v_exp_f32 v74, v74
    v_exp_f32 v75, v75
    v_exp_f32 v44, v44
    v_exp_f32 v45, v45
    v_smfmac_f32_32x32x32_bf16 v[132:147], v[28:31], v[68:75], v3
    v_exp_f32 v46, v46
    v_exp_f32 v47, v47
    v_exp_f32 v48, v48
    v_mfma_f32_32x32x16_bf16 v[60:75], v[32:35], v[8:11], 0
    s_waitcnt vmcnt(4)
    v_exp_f32 v49, v49
    v_exp_f32 v50, v50
    v_exp_f32 v51, v51
    v_exp_f32 v52, v52
    v_exp_f32 v53, v53
    v_smfmac_f32_32x32x32_bf16 v[84:99], v[36:39], v[44:51], v3
    s_waitcnt vmcnt(3)
    v_exp_f32 v54, v54
    v_exp_f32 v55, v55
    v_exp_f32 v56, v56
    v_exp_f32 v57, v57
    v_exp_f32 v58, v58
    v_exp_f32 v59, v59
    v_exp_f32 v60, v60
    v_exp_f32 v61, v61
    v_smfmac_f32_32x32x32_bf16 v[84:99], v[40:43], v[52:59], v3
    v_exp_f32 v62, v62
    v_exp_f32 v63, v63
    v_exp_f32 v64, v64
    v_mfma_f32_32x32x16_bf16 v[44:59], v[32:35], v[12:15], 0
    v_exp_f32 v65, v65
    v_exp_f32 v66, v66
    v_exp_f32 v67, v67
    v_exp_f32 v68, v68
    v_exp_f32 v69, v69
    v_smfmac_f32_32x32x32_bf16 v[100:115], v[36:39], v[60:67], v3
    v_exp_f32 v70, v70
    v_exp_f32 v71, v71
    v_exp_f32 v72, v72
    v_exp_f32 v73, v73
    v_exp_f32 v74, v74
    v_exp_f32 v75, v75
    v_exp_f32 v44, v44
    v_exp_f32 v45, v45
    v_smfmac_f32_32x32x32_bf16 v[100:115], v[40:43], v[68:75], v3
    v_exp_f32 v46, v46
    v_exp_f32 v47, v47
    v_exp_f32 v48, v48
    v_mfma_f32_32x32x16_bf16 v[60:75], v[32:35], v[16:19], 0
    v_exp_f32 v49, v49
    v_exp_f32 v50, v50
    v_exp_f32 v51, v51
    v_exp_f32 v52, v52
    v_exp_f32 v53, v53
    v_smfmac_f32_32x32x32_bf16 v[116:131], v[36:39], v[44:51], v3
    v_exp_f32 v54, v54
    v_exp_f32 v55, v55
    v_exp_f32 v56, v56
    v_exp_f32 v57, v57
    v_exp_f32 v58, v58
    v_exp_f32 v59, v59
    v_exp_f32 v60, v60
    v_exp_f32 v61, v61
    v_smfmac_f32_32x32x32_bf16 v[116:131], v[40:43], v[52:59], v3
    s_waitcnt vmcnt(2)
    v_mov_b32 v0, s54
    ds_read_b32 v0, v0 offset:96
    v_exp_f32 v62, v62
    v_exp_f32 v63, v63
    v_exp_f32 v64, v64
    v_mfma_f32_32x32x16_bf16 v[44:59], v[148:151], v[4:7], 0
    v_exp_f32 v65, v65
    v_exp_f32 v66, v66
    v_exp_f32 v67, v67
    v_exp_f32 v68, v68
    v_exp_f32 v69, v69
    v_smfmac_f32_32x32x32_bf16 v[132:147], v[36:39], v[60:67], v3
    v_exp_f32 v70, v70
    v_exp_f32 v71, v71
    v_exp_f32 v72, v72
    v_exp_f32 v73, v73
    v_exp_f32 v74, v74
    v_exp_f32 v75, v75
    v_exp_f32 v44, v44
    v_exp_f32 v45, v45
    v_smfmac_f32_32x32x32_bf16 v[132:147], v[40:43], v[68:75], v3
    s_waitcnt lgkmcnt(0)
    v_readfirstlane_b32 s12, v0
    v_exp_f32 v46, v46
    v_exp_f32 v47, v47
    v_exp_f32 v48, v48
    v_mfma_f32_32x32x16_bf16 v[60:75], v[148:151], v[8:11], 0
    s_waitcnt vmcnt(1)
    s_bitcmp1_b32 s12, 0
    s_cbranch_scc0 L_kl0
L_kl0d:
    v_add_u32 v0, s52, v1
    v_add_u32 v152, s52, v2
    v_exp_f32 v49, v49
    v_exp_f32 v50, v50
    v_exp_f32 v51, v51
    v_exp_f32 v52, v52
    v_exp_f32 v53, v53
    v_smfmac_f32_32x32x32_bf16 v[84:99], v[76:79], v[44:51], v3
    s_waitcnt vmcnt(0)
    ds_read_b128 v[20:23], v0 offset:0
    v_exp_f32 v54, v54
    v_exp_f32 v55, v55
    v_exp_f32 v56, v56
    v_exp_f32 v57, v57
    v_exp_f32 v58, v58
    v_exp_f32 v59, v59
    v_exp_f32 v60, v60
    v_exp_f32 v61, v61
    v_smfmac_f32_32x32x32_bf16 v[84:99], v[80:83], v[52:59], v3
    s_mov_b64 exec, s[62:63]
    ds_read_b128 v[24:27], v152 offset:1024
    ds_read_b128 v[28:31], v152 offset:1536
    s_mov_b64 exec, -1
    v_exp_f32 v62, v62
    v_exp_f32 v63, v63
    v_exp_f32 v64, v64
    v_mfma_f32_32x32x16_bf16 v[44:59], v[148:151], v[12:15], 0
    ds_read_b128 v[32:35], v0 offset:2048
    v_exp_f32 v65, v65
    v_exp_f32 v66, v66
    v_exp_f32 v67, v67
    v_exp_f32 v68, v68
    v_exp_f32 v69, v69
    v_smfmac_f32_32x32x32_bf16 v[100:115], v[76:79], v[60:67], v3
    s_mov_b64 exec, s[62:63]
    ds_read_b128 v[36:39], v152 offset:3072
    ds_read_b128 v[40:43], v152 offset:3584
    s_mov_b64 exec, -1
    v_exp_f32 v70, v70
    v_exp_f32 v71, v71
    v_exp_f32 v72, v72
    v_exp_f32 v73, v73
    v_exp_f32 v74, v74
    v_exp_f32 v75, v75
    v_exp_f32 v44, v44
    v_exp_f32 v45, v45
    v_smfmac_f32_32x32x32_bf16 v[100:115], v[80:83], v[68:75], v3
    s_mov_b64 exec, 1
    ds_add_u32 v153, v154 offset:128
    s_mov_b64 exec, -1
    v_exp_f32 v46, v46
    v_exp_f32 v47, v47
    v_exp_f32 v48, v48
    v_mfma_f32_32x32x16_bf16 v[60:75], v[148:151], v[16:19], 0
    s_add_u32 s56, s45, 5
    s_and_b32 s56, s56, 15
    s_lshl_b32 s56, s56, 11
    s_add_u32 s56, s56, s90
    buffer_load_dwordx4 v[148:151], v1, s[8:11], s56 offen sc1
    v_exp_f32 v49, v49
    v_exp_f32 v50, v50
    v_exp_f32 v51, v51
    v_exp_f32 v52, v52
    v_exp_f32 v53, v53
    v_smfmac_f32_32x32x32_bf16 v[116:131], v[76:79], v[44:51], v3
    v_exp_f32 v54, v54
    v_exp_f32 v55, v55
    v_exp_f32 v56, v56
    v_exp_f32 v57, v57
    v_exp_f32 v58, v58
    v_exp_f32 v59, v59
    v_exp_f32 v60, v60
    v_exp_f32 v61, v61
    v_smfmac_f32_32x32x32_bf16 v[116:131], v[80:83], v[52:59], v3
    s_waitcnt lgkmcnt(4)
    s_cbranch_vccnz L_fl1
L_fl1d:
    v_exp_f32 v62, v62
    v_exp_f32 v63, v63
    v_exp_f32 v64, v64
    v_mfma_f32_32x32x16_bf16 v[44:59], v[20:23], v[4:7], 0
    v_exp_f32 v65, v65
    v_exp_f32 v66, v66
    v_exp_f32 v67, v67
    v_exp_f32 v68, v68
    v_exp_f32 v69, v69
    v_smfmac_f32_32x32x32_bf16 v[132:147], v[76:79], v[60:67], v3
    s_mov_b64 exec, s[62:63]
    buffer_load_dwordx4 v[76:79], v2, s[8:11], s56 offen offset:1024 sc1
    s_mov_b64 exec, -1
    v_exp_f32 v70, v70
    v_exp_f32 v71, v71
    v_exp_f32 v72, v72
    v_exp_f32 v73, v73
    v_exp_f32 v74, v74
    v_exp_f32 v75, v75
    v_exp_f32 v44, v44
    v_exp_f32 v45, v45
    v_smfmac_f32_32x32x32_bf16 v[132:147], v[80:83], v[68:75], v3
    s_mov_b64 exec, s[62:63]
    buffer_load_dwordx4 v[80:83], v2, s[8:11], s56 offen offset:1536 sc1
    s_mov_b64 exec, -1
    v_exp_f32 v46, v46
    v_exp_f32 v47, v47
    v_exp_f32 v48, v48
    v_mfma_f32_32x32x16_bf16 v[60:75], v[20:23], v[8:11], 0
    v_exp_f32 v49, v49
    v_exp_f32 v50, v50
    v_exp_f32 v51, v51
    v_exp_f32 v52, v52
    v_exp_f32 v53, v53
    v_smfmac_f32_32x32x32_bf16 v[84:99], v[24:27], v[44:51], v3
    s_cbranch_vccnz L_np1
    s_setprio 1
L_np1:
    v_exp_f32 v54, v54
    v_exp_f32 v55, v55
    v_exp_f32 v56, v56
    v_exp_f32 v57, v57
    v_exp_f32 v58, v58
    v_exp_f32 v59, v59
    v_exp_f32 v60, v60
    v_exp_f32 v61, v61
    v_smfmac_f32_32x32x32_bf16 v[84:99], v[28:31], v[52:59], v3
    v_exp_f32 v62, v62
    v_exp_f32 v63, v63
    v_exp_f32 v64, v64
    v_mfma_f32_32x32x16_bf16 v[44:59], v[20:23], v[12:15], 0
    v_exp_f32 v65, v65
    v_exp_f32 v66, v66
    v_exp_f32 v67, v67
    v_exp_f32 v68, v68
    v_exp_f32 v69, v69
    v_smfmac_f32_32x32x32_bf16 v[100:115], v[24:27], v[60:67], v3
    v_exp_f32 v70, v70
    v_exp_f32 v71, v71
    v_exp_f32 v72, v72
    v_exp_f32 v73, v73
    v_exp_f32 v74, v74
    v_exp_f32 v75, v75
    v_exp_f32 v44, v44
    v_exp_f32 v45, v45
    v_smfmac_f32_32x32x32_bf16 v[100:115], v[28:31], v[68:75], v3
    v_exp_f32 v46, v46
    v_exp_f32 v47, v47
    v_exp_f32 v48, v48
    v_mfma_f32_32x32x16_bf16 v[60:75], v[20:23], v[16:19], 0
    v_exp_f32 v49, v49
    v_exp_f32 v50, v50
    v_exp_f32 v51, v51
    v_exp_f32 v52, v52
    v_exp_f32 v53, v53
    v_smfmac_f32_32x32x32_bf16 v[116:131], v[24:27], v[44:51], v3
    v_exp_f32 v54, v54
    v_exp_f32 v55, v55
    v_exp_f32 v56, v56
    v_exp_f32 v57, v57
    v_exp_f32 v58, v58
    v_exp_f32 v59, v59
    v_exp_f32 v60, v60
    v_exp_f32 v61, v61
    v_smfmac_f32_32x32x32_bf16 v[116:131], v[28:31], v[52:59], v3
    s_waitcnt lgkmcnt(1)
    v_exp_f32 v62, v62
    v_exp_f32 v63, v63
    v_exp_f32 v64, v64
    v_mfma_f32_32x32x16_bf16 v[44:59], v[32:35], v[4:7], 0
    v_exp_f32 v65, v65
    v_exp_f32 v66, v66
    v_exp_f32 v67, v67
    v_exp_f32 v68, v68
    v_exp_f32 v69, v69
    v_smfmac_f32_32x32x32_bf16 v[132:147], v[24:27], v[60:67], v3
    v_exp_f32 v70, v70
    v_exp_f32 v71, v71
    v_exp_f32 v72, v72
    v_exp_f32 v73, v73
    v_exp_f32 v74, v74
    v_exp_f32 v75, v75
    v_exp_f32 v44, v44
    v_exp_f32 v45, v45
    v_smfmac_f32_32x32x32_bf16 v[132:147], v[28:31], v[68:75], v3
    v_exp_f32 v46, v46
    v_exp_f32 v47, v47
    v_exp_f32 v48, v48
    v_mfma_f32_32x32x16_bf16 v[60:75], v[32:35], v[8:11], 0
    v_exp_f32 v49, v49
    v_exp_f32 v50, v50
    v_exp_f32 v51, v51
    v_exp_f32 v52, v52
    v_exp_f32 v53, v53
    v_smfmac_f32_32x32x32_bf16 v[84:99], v[36:39], v[44:51], v3
    v_exp_f32 v54, v54
    v_exp_f32 v55, v55
    v_exp_f32 v56, v56
    v_exp_f32 v57, v57
    v_exp_f32 v58, v58
    v_exp_f32 v59, v59
    v_exp_f32 v60, v60
    v_exp_f32 v61, v61
    v_smfmac_f32_32x32x32_bf16 v[84:99], v[40:43], v[52:59], v3
    v_exp_f32 v62, v62
    v_exp_f32 v63, v63
    v_exp_f32 v64, v64
    v_mfma_f32_32x32x16_bf16 v[44:59], v[32:35], v[12:15], 0
    v_exp_f32 v65, v65
    v_exp_f32 v66, v66
    v_exp_f32 v67, v67
    v_exp_f32 v68, v68
    v_exp_f32 v69, v69
    v_smfmac_f32_32x32x32_bf16 v[100:115], v[36:39], v[60:67], v3
    v_exp_f32 v70, v70
    v_exp_f32 v71, v71
    v_exp_f32 v72, v72
    v_exp_f32 v73, v73
    v_exp_f32 v74, v74
    v_exp_f32 v75, v75
    v_exp_f32 v44, v44
    v_exp_f32 v45, v45
    v_smfmac_f32_32x32x32_bf16 v[100:115], v[40:43], v[68:75], v3
    v_exp_f32 v46, v46
    v_exp_f32 v47, v47
    v_exp_f32 v48, v48
    v_mfma_f32_32x32x16_bf16 v[60:75], v[32:35], v[16:19], 0
    v_exp_f32 v49, v49
    v_exp_f32 v50, v50
    v_exp_f32 v51, v51
    v_exp_f32 v52, v52
    v_exp_f32 v53, v53
    v_smfmac_f32_32x32x32_bf16 v[116:131], v[36:39], v[44:51], v3
    v_exp_f32 v54, v54
    v_exp_f32 v55, v55
    v_exp_f32 v56, v56
    v_exp_f32 v57, v57
    v_exp_f32 v58, v58
    v_exp_f32 v59, v59
    v_exp_f32 v60, v60
    v_exp_f32 v61, v61
    v_smfmac_f32_32x32x32_bf16 v[116:131], v[40:43], v[52:59], v3
    s_waitcnt vmcnt(2)
    s_cbranch_vccnz L_ld1
L_ld1d:
    v_exp_f32 v62, v62
    v_exp_f32 v63, v63
    v_exp_f32 v64, v64
    v_mfma_f32_32x32x16_bf16 v[44:59], v[148:151], v[4:7], 0
    v_exp_f32 v65, v65
    v_exp_f32 v66, v66
    v_exp_f32 v67, v67
    v_exp_f32 v68, v68
    v_exp_f32 v69, v69
    v_smfmac_f32_32x32x32_bf16 v[132:147], v[36:39], v[60:67], v3
    v_exp_f32 v70, v70
    v_exp_f32 v71, v71
    v_exp_f32 v72, v72
    v_exp_f32 v73, v73
    v_exp_f32 v74, v74
    v_exp_f32 v75, v75
    v_exp_f32 v44, v44
    v_exp_f32 v45, v45
    v_smfmac_f32_32x32x32_bf16 v[132:147], v[40:43], v[68:75], v3
    v_mov_b32 v0, s54
    ds_read_b32 v0, v0 offset:96
    v_exp_f32 v46, v46
    v_exp_f32 v47, v47
    v_exp_f32 v48, v48
    v_mfma_f32_32x32x16_bf16 v[60:75], v[148:151], v[8:11], 0
    s_waitcnt vmcnt(1)
    v_exp_f32 v49, v49
    v_exp_f32 v50, v50
    v_exp_f32 v51, v51
    v_exp_f32 v52, v52
    v_exp_f32 v53, v53
    v_smfmac_f32_32x32x32_bf16 v[84:99], v[76:79], v[44:51], v3
    s_waitcnt vmcnt(0)
    v_exp_f32 v54, v54
    v_exp_f32 v55, v55
    v_exp_f32 v56, v56
    v_exp_f32 v57, v57
    v_exp_f32 v58, v58
    v_exp_f32 v59, v59
    v_exp_f32 v60, v60
    v_exp_f32 v61, v61
    v_smfmac_f32_32x32x32_bf16 v[84:99], v[80:83], v[52:59], v3
    s_waitcnt lgkmcnt(0)
    v_readfirstlane_b32 s12, v0
    v_exp_f32 v62, v62
    v_exp_f32 v63, v63
    v_exp_f32 v64, v64
    v_mfma_f32_32x32x16_bf16 v[44:59], v[148:151], v[12:15], 0
    s_bitcmp1_b32 s12, 1
    s_cbranch_scc0 L_kl1
L_kl1d:
    v_add_u32 v0, s44, v1
    v_add_u32 v152, s44, v2
    v_exp_f32 v65, v65
    v_exp_f32 v66, v66
    v_exp_f32 v67, v67
    v_exp_f32 v68, v68
    v_exp_f32 v69, v69
    v_smfmac_f32_32x32x32_bf16 v[100:115], v[76:79], v[60:67], v3
    ds_read_b128 v[20:23], v0 offset:0
    v_exp_f32 v70, v70
    v_exp_f32 v71, v71
    v_exp_f32 v72, v72
    v_exp_f32 v73, v73
    v_exp_f32 v74, v74
    v_exp_f32 v75, v75
    v_exp_f32 v44, v44
    v_exp_f32 v45, v45
    v_smfmac_f32_32x32x32_bf16 v[100:115], v[80:83], v[68:75], v3
    s_mov_b64 exec, s[62:63]
    ds_read_b128 v[24:27], v152 offset:1024
    ds_read_b128 v[28:31], v152 offset:1536
    s_mov_b64 exec, -1
    v_exp_f32 v46, v46
    v_exp_f32 v47, v47
    v_exp_f32 v48, v48
    v_mfma_f32_32x32x16_bf16 v[60:75], v[148:151], v[16:19], 0
    ds_read_b128 v[32:35], v0 offset:2048
    v_exp_f32 v49, v49
    v_exp_f32 v50, v50
    v_exp_f32 v51, v51
    v_exp_f32 v52, v52
    v_exp_f32 v53, v53
    v_smfmac_f32_32x32x32_bf16 v[116:131], v[76:79], v[44:51], v3
    s_mov_b64 exec, s[62:63]
    ds_read_b128 v[36:39], v152 offset:3072
    ds_read_b128 v[40:43], v152 offset:3584
    s_mov_b64 exec, -1
    v_exp_f32 v54, v54
    v_exp_f32 v55, v55
    v_exp_f32 v56, v56
    v_exp_f32 v57, v57
    v_exp_f32 v58, v58
    v_exp_f32 v59, v59
    v_exp_f32 v60, v60
    v_exp_f32 v61, v61
    v_smfmac_f32_32x32x32_bf16 v[116:131], v[80:83], v[52:59], v3
    s_waitcnt lgkmcnt(3)
    ds_read_b128 v[148:151], v0 offset:4096
    v_exp_f32 v62, v62
    v_exp_f32 v63, v63
    v_exp_f32 v64, v64
    v_mfma_f32_32x32x16_bf16 v[44:59], v[20:23], v[4:7], 0
    v_exp_f32 v65, v65
    v_exp_f32 v66, v66
    v_exp_f32 v67, v67
    v_exp_f32 v68, v68
    v_exp_f32 v69, v69
    v_smfmac_f32_32x32x32_bf16 v[132:147], v[76:79], v[60:67], v3
    v_exp_f32 v70, v70
    v_exp_f32 v71, v71
    v_exp_f32 v72, v72
    v_exp_f32 v73, v73
    v_exp_f32 v74, v74
    v_exp_f32 v75, v75
    v_exp_f32 v44, v44
    v_exp_f32 v45, v45
    v_smfmac_f32_32x32x32_bf16 v[132:147], v[80:83], v[68:75], v3
    s_mov_b64 exec, s[62:63]
    ds_read_b128 v[76:79], v152 offset:5120
    ds_read_b128 v[80:83], v152 offset:5632
    s_mov_b64 exec, -1
    v_exp_f32 v46, v46
    v_exp_f32 v47, v47
    v_exp_f32 v48, v48
    v_mfma_f32_32x32x16_bf16 v[60:75], v[20:23], v[8:11], 0
    s_mov_b64 exec, 1
    ds_add_u32 v153, v154 offset:132
    s_mov_b64 exec, -1
    v_exp_f32 v49, v49
    v_exp_f32 v50, v50
    v_exp_f32 v51, v51
    v_exp_f32 v52, v52
    v_exp_f32 v53, v53
    v_smfmac_f32_32x32x32_bf16 v[84:99], v[24:27], v[44:51], v3
    s_setprio 1
    v_exp_f32 v54, v54
    v_exp_f32 v55, v55
    v_exp_f32 v56, v56
    v_exp_f32 v57, v57
    v_exp_f32 v58, v58
    v_exp_f32 v59, v59
    v_exp_f32 v60, v60
    v_exp_f32 v61, v61
    v_smfmac_f32_32x32x32_bf16 v[84:99], v[28:31], v[52:59], v3
    v_exp_f32 v62, v62
    v_exp_f32 v63, v63
    v_exp_f32 v64, v64
    v_mfma_f32_32x32x16_bf16 v[44:59], v[20:23], v[12:15], 0
    s_cbranch_vccz L_fl2
L_fl2d:
    v_exp_f32 v65, v65
    v_exp_f32 v66, v66
    v_exp_f32 v67, v67
    v_exp_f32 v68, v68
    v_exp_f32 v69, v69
    v_smfmac_f32_32x32x32_bf16 v[100:115], v[24:27], v[60:67], v3
    v_exp_f32 v70, v70
    v_exp_f32 v71, v71
    v_exp_f32 v72, v72
    v_exp_f32 v73, v73
    v_exp_f32 v74, v74
    v_exp_f32 v75, v75
    v_exp_f32 v44, v44
    v_exp_f32 v45, v45
    v_smfmac_f32_32x32x32_bf16 v[100:115], v[28:31], v[68:75], v3
    v_exp_f32 v46, v46
    v_exp_f32 v47, v47
    v_exp_f32 v48, v48
    v_mfma_f32_32x32x16_bf16 v[60:75], v[20:23], v[16:19], 0
    v_exp_f32 v49, v49
    v_exp_f32 v50, v50
    v_exp_f32 v51, v51
    v_exp_f32 v52, v52
    v_exp_f32 v53, v53
    v_smfmac_f32_32x32x32_bf16 v[116:131], v[24:27], v[44:51], v3
    v_exp_f32 v54, v54
    v_exp_f32 v55, v55
    v_exp_f32 v56, v56
    v_exp_f32 v57, v57
    v_exp_f32 v58, v58
    v_exp_f32 v59, v59
    v_exp_f32 v60, v60
    v_exp_f32 v61, v61
    v_smfmac_f32_32x32x32_bf16 v[116:131], v[28:31], v[52:59], v3
    s_waitcnt lgkmcnt(4)
    v_exp_f32 v62, v62
    v_exp_f32 v63, v63
    v_exp_f32 v64, v64
    v_mfma_f32_32x32x16_bf16 v[44:59], v[32:35], v[4:7], 0
    v_exp_f32 v65, v65
    v_exp_f32 v66, v66
    v_exp_f32 v67, v67
    v_exp_f32 v68, v68
    v_exp_f32 v69, v69
    v_smfmac_f32_32x32x32_bf16 v[132:147], v[24:27], v[60:67], v3
    v_exp_f32 v70, v70
    v_exp_f32 v71, v71
    v_exp_f32 v72, v72
    v_exp_f32 v73, v73
    v_exp_f32 v74, v74
    v_exp_f32 v75, v75
    v_exp_f32 v44, v44
    v_exp_f32 v45, v45
    v_smfmac_f32_32x32x32_bf16 v[132:147], v[28:31], v[68:75], v3
    v_exp_f32 v46, v46
    v_exp_f32 v47, v47
    v_exp_f32 v48, v48
    v_mfma_f32_32x32x16_bf16 v[60:75], v[32:35], v[8:11], 0
    v_exp_f32 v49, v49
    v_exp_f32 v50, v50
    v_exp_f32 v51, v51
    v_exp_f32 v52, v52
    v_exp_f32 v53, v53
    v_smfmac_f32_32x32x32_bf16 v[84:99], v[36:39], v[44:51], v3
    v_exp_f32 v54, v54
    v_exp_f32 v55, v55
    v_exp_f32 v56, v56
    v_exp_f32 v57, v57
    v_exp_f32 v58, v58
    v_exp_f32 v59, v59
    v_exp_f32 v60, v60
    v_exp_f32 v61, v61
    v_smfmac_f32_32x32x32_bf16 v[84:99], v[40:43], v[52:59], v3
    v_exp_f32 v62, v62
    v_exp_f32 v63, v63
    v_exp_f32 v64, v64
    v_mfma_f32_32x32x16_bf16 v[44:59], v[32:35], v[12:15], 0
    v_exp_f32 v65, v65
    v_exp_f32 v66, v66
    v_exp_f32 v67, v67
    v_exp_f32 v68, v68
    v_exp_f32 v69, v69
    v_smfmac_f32_32x32x32_bf16 v[100:115], v[36:39], v[60:67], v3
    v_exp_f32 v70, v70
    v_exp_f32 v71, v71
    v_exp_f32 v72, v72
    v_exp_f32 v73, v73
    v_exp_f32 v74, v74
    v_exp_f32 v75, v75
    v_exp_f32 v44, v44
    v_exp_f32 v45, v45
    v_smfmac_f32_32x32x32_bf16 v[100:115], v[40:43], v[68:75], v3
    v_exp_f32 v46, v46
    v_exp_f32 v47, v47
    v_exp_f32 v48, v48
    v_mfma_f32_32x32x16_bf16 v[60:75], v[32:35], v[16:19], 0
    v_exp_f32 v49, v49
    v_exp_f32 v50, v50
    v_exp_f32 v51, v51
    v_exp_f32 v52, v52
    v_exp_f32 v53, v53
    v_smfmac_f32_32x32x32_bf16 v[116:131], v[36:39], v[44:51], v3
    v_exp_f32 v54, v54
    v_exp_f32 v55, v55
    v_exp_f32 v56, v56
    v_exp_f32 v57, v57
    v_exp_f32 v58, v58
    v_exp_f32 v59, v59
    v_exp_f32 v60, v60
    v_exp_f32 v61, v61
    v_smfmac_f32_32x32x32_bf16 v[116:131], v[40:43], v[52:59], v3
    s_waitcnt lgkmcnt(1)
    v_exp_f32 v62, v62
    v_exp_f32 v63, v63
    v_exp_f32 v64, v64
    v_mfma_f32_32x32x16_bf16 v[44:59], v[148:151], v[4:7], 0
    v_exp_f32 v65, v65
    v_exp_f32 v66, v66
    v_exp_f32 v67, v67
    v_exp_f32 v68, v68
    v_exp_f32 v69, v69
    v_smfmac_f32_32x32x32_bf16 v[132:147], v[36:39], v[60:67], v3
    s_cbranch_vccz L_ld2
L_ld2d:
    v_exp_f32 v70, v70
    v_exp_f32 v71, v71
    v_exp_f32 v72, v72
    v_exp_f32 v73, v73
    v_exp_f32 v74, v74
    v_exp_f32 v75, v75
    v_exp_f32 v44, v44
    v_exp_f32 v45, v45
    v_smfmac_f32_32x32x32_bf16 v[132:147], v[40:43], v[68:75], v3
    v_mov_b32 v0, s54
    ds_read_b32 v0, v0 offset:96
    v_exp_f32 v46, v46
    v_exp_f32 v47, v47
    v_exp_f32 v48, v48
    v_mfma_f32_32x32x16_bf16 v[60:75], v[148:151], v[8:11], 0
    v_exp_f32 v49, v49
    v_exp_f32 v50, v50
    v_exp_f32 v51, v51
    v_exp_f32 v52, v52
    v_exp_f32 v53, v53
    v_smfmac_f32_32x32x32_bf16 v[84:99], v[76:79], v[44:51], v3
    v_exp_f32 v54, v54
    v_exp_f32 v55, v55
    v_exp_f32 v56, v56
    v_exp_f32 v57, v57
    v_exp_f32 v58, v58
    v_exp_f32 v59, v59
    v_exp_f32 v60, v60
    v_exp_f32 v61, v61
    v_smfmac_f32_32x32x32_bf16 v[84:99], v[80:83], v[52:59], v3
    s_waitcnt lgkmcnt(0)
    v_readfirstlane_b32 s12, v0
    v_exp_f32 v62, v62
    v_exp_f32 v63, v63
    v_exp_f32 v64, v64
    v_mfma_f32_32x32x16_bf16 v[44:59], v[148:151], v[12:15], 0
    s_bitcmp1_b32 s12, 2
    s_cbranch_scc0 L_kl2
L_kl2d:
    v_add_u32 v0, s44, v1
    v_add_u32 v152, s44, v2
    v_exp_f32 v65, v65
    v_exp_f32 v66, v66
    v_exp_f32 v67, v67
    v_exp_f32 v68, v68
    v_exp_f32 v69, v69
    v_smfmac_f32_32x32x32_bf16 v[100:115], v[76:79], v[60:67], v3
    ds_read_b128 v[20:23], v0 offset:0
    v_exp_f32 v70, v70
    v_exp_f32 v71, v71
    v_exp_f32 v72, v72
    v_exp_f32 v73, v73
    v_exp_f32 v74, v74
    v_exp_f32 v75, v75
    v_exp_f32 v44, v44
    v_exp_f32 v45, v45
    v_smfmac_f32_32x32x32_bf16 v[100:115], v[80:83], v[68:75], v3
    s_mov_b64 exec, s[62:63]
    ds_read_b128 v[24:27], v152 offset:1024
    ds_read_b128 v[28:31], v152 offset:1536
    s_mov_b64 exec, -1
    v_exp_f32 v46, v46
    v_exp_f32 v47, v47
    v_exp_f32 v48, v48
    v_mfma_f32_32x32x16_bf16 v[60:75], v[148:151], v[16:19], 0
    ds_read_b128 v[32:35], v0 offset:2048
    v_exp_f32 v49, v49
    v_exp_f32 v50, v50
    v_exp_f32 v51, v51
    v_exp_f32 v52, v52
    v_exp_f32 v53, v53
    v_smfmac_f32_32x32x32_bf16 v[116:131], v[76:79], v[44:51], v3
    s_mov_b64 exec, s[62:63]
    ds_read_b128 v[36:39], v152 offset:3072
    ds_read_b128 v[40:43], v152 offset:3584
    s_mov_b64 exec, -1
    v_exp_f32 v54, v54
    v_exp_f32 v55, v55
    v_exp_f32 v56, v56
    v_exp_f32 v57, v57
    v_exp_f32 v58, v58
    v_exp_f32 v59, v59
    v_exp_f32 v60, v60
    v_exp_f32 v61, v61
    v_smfmac_f32_32x32x32_bf16 v[116:131], v[80:83], v[52:59], v3
    s_waitcnt lgkmcnt(3)
    ds_read_b128 v[148:151], v0 offset:4096
    v_exp_f32 v62, v62
    v_exp_f32 v63, v63
    v_exp_f32 v64, v64
    v_mfma_f32_32x32x16_bf16 v[44:59], v[20:23], v[4:7], 0
    v_exp_f32 v65, v65
    v_exp_f32 v66, v66
    v_exp_f32 v67, v67
    v_exp_f32 v68, v68
    v_exp_f32 v69, v69
    v_smfmac_f32_32x32x32_bf16 v[132:147], v[76:79], v[60:67], v3
    v_exp_f32 v70, v70
    v_exp_f32 v71, v71
    v_exp_f32 v72, v72
    v_exp_f32 v73, v73
    v_exp_f32 v74, v74
    v_exp_f32 v75, v75
    v_exp_f32 v44, v44
    v_exp_f32 v45, v45
    v_smfmac_f32_32x32x32_bf16 v[132:147], v[80:83], v[68:75], v3
    s_mov_b64 exec, s[62:63]
    ds_read_b128 v[76:79], v152 offset:5120
    ds_read_b128 v[80:83], v152 offset:5632
    s_mov_b64 exec, -1
    v_exp_f32 v46, v46
    v_exp_f32 v47, v47
    v_exp_f32 v48, v48
    v_mfma_f32_32x32x16_bf16 v[60:75], v[20:23], v[8:11], 0
    s_mov_b64 exec, 1
    ds_add_u32 v153, v154 offset:4
    s_mov_b64 exec, -1
    v_exp_f32 v49, v49
    v_exp_f32 v50, v50
    v_exp_f32 v51, v51
    v_exp_f32 v52, v52
    v_exp_f32 v53, v53
    v_smfmac_f32_32x32x32_bf16 v[84:99], v[24:27], v[44:51], v3
    v_exp_f32 v54, v54
    v_exp_f32 v55, v55
    v_exp_f32 v56, v56
    v_exp_f32 v57, v57
    v_exp_f32 v58, v58
    v_exp_f32 v59, v59
    v_exp_f32 v60, v60
    v_exp_f32 v61, v61
    v_smfmac_f32_32x32x32_bf16 v[84:99], v[28:31], v[52:59], v3
    v_mov_b32 v0, s54
    ds_read_b32 v0, v0 offset:96
    v_exp_f32 v62, v62
    v_exp_f32 v63, v63
    v_exp_f32 v64, v64
    v_mfma_f32_32x32x16_bf16 v[44:59], v[20:23], v[12:15], 0
    v_exp_f32 v65, v65
    v_exp_f32 v66, v66
    v_exp_f32 v67, v67
    v_exp_f32 v68, v68
    v_exp_f32 v69, v69
    v_smfmac_f32_32x32x32_bf16 v[100:115], v[24:27], v[60:67], v3
    v_exp_f32 v70, v70
    v_exp_f32 v71, v71
    v_exp_f32 v72, v72
    v_exp_f32 v73, v73
    v_exp_f32 v74, v74
    v_exp_f32 v75, v75
    v_exp_f32 v44, v44
    v_exp_f32 v45, v45
    v_smfmac_f32_32x32x32_bf16 v[100:115], v[28:31], v[68:75], v3
    s_waitcnt lgkmcnt(0)
    v_readfirstlane_b32 s12, v0
    v_exp_f32 v46, v46
    v_exp_f32 v47, v47
    v_exp_f32 v48, v48
    v_mfma_f32_32x32x16_bf16 v[60:75], v[20:23], v[16:19], 0
    s_bitcmp1_b32 s12, 3
    s_cbranch_scc0 L_kl3
L_kl3d:
    v_add_u32 v0, s53, v1
    v_add_u32 v152, s53, v2
    v_exp_f32 v49, v49
    v_exp_f32 v50, v50
    v_exp_f32 v51, v51
    v_exp_f32 v52, v52
    v_exp_f32 v53, v53
    v_smfmac_f32_32x32x32_bf16 v[116:131], v[24:27], v[44:51], v3
    ds_read_b128 v[20:23], v0 offset:0
    v_exp_f32 v54, v54
    v_exp_f32 v55, v55
    v_exp_f32 v56, v56
    v_exp_f32 v57, v57
    v_exp_f32 v58, v58
    v_exp_f32 v59, v59
    v_exp_f32 v60, v60
    v_exp_f32 v61, v61
    v_smfmac_f32_32x32x32_bf16 v[116:131], v[28:31], v[52:59], v3
    v_exp_f32 v62, v62
    v_exp_f32 v63, v63
    v_exp_f32 v64, v64
    v_mfma_f32_32x32x16_bf16 v[44:59], v[32:35], v[4:7], 0
    v_exp_f32 v65, v65
    v_exp_f32 v66, v66
    v_exp_f32 v67, v67
    v_exp_f32 v68, v68
    v_exp_f32 v69, v69
    v_smfmac_f32_32x32x32_bf16 v[132:147], v[24:27], v[60:67], v3
    v_exp_f32 v70, v70
    v_exp_f32 v71, v71
    v_exp_f32 v72, v72
    v_exp_f32 v73, v73
    v_exp_f32 v74, v74
    v_exp_f32 v75, v75
    v_exp_f32 v44, v44
    v_exp_f32 v45, v45
    v_smfmac_f32_32x32x32_bf16 v[132:147], v[28:31], v[68:75], v3
    s_mov_b64 exec, s[62:63]
    ds_read_b128 v[24:27], v152 offset:1024
    ds_read_b128 v[28:31], v152 offset:1536
    s_mov_b64 exec, -1
    v_exp_f32 v46, v46
    v_exp_f32 v47, v47
    v_exp_f32 v48, v48
    v_mfma_f32_32x32x16_bf16 v[60:75], v[32:35], v[8:11], 0
    v_exp_f32 v49, v49
    v_exp_f32 v50, v50
    v_exp_f32 v51, v51
    v_exp_f32 v52, v52
    v_exp_f32 v53, v53
    v_smfmac_f32_32x32x32_bf16 v[84:99], v[36:39], v[44:51], v3
    v_exp_f32 v54, v54
    v_exp_f32 v55, v55
    v_exp_f32 v56, v56
    v_exp_f32 v57, v57
    v_exp_f32 v58, v58
    v_exp_f32 v59, v59
    v_exp_f32 v60, v60
    v_exp_f32 v61, v61
    v_smfmac_f32_32x32x32_bf16 v[84:99], v[40:43], v[52:59], v3
    v_exp_f32 v62, v62
    v_exp_f32 v63, v63
    v_exp_f32 v64, v64
    v_mfma_f32_32x32x16_bf16 v[44:59], v[32:35], v[12:15], 0
    v_exp_f32 v65, v65
    v_exp_f32 v66, v66
    v_exp_f32 v67, v67
    v_exp_f32 v68, v68
    v_exp_f32 v69, v69
    v_smfmac_f32_32x32x32_bf16 v[100:115], v[36:39], v[60:67], v3
    v_exp_f32 v70, v70
    v_exp_f32 v71, v71
    v_exp_f32 v72, v72
    v_exp_f32 v73, v73
    v_exp_f32 v74, v74
    v_exp_f32 v75, v75
    v_exp_f32 v44, v44
    v_exp_f32 v45, v45
    v_smfmac_f32_32x32x32_bf16 v[100:115], v[40:43], v[68:75], v3
    v_exp_f32 v46, v46
    v_exp_f32 v47, v47
    v_exp_f32 v48, v48
    v_mfma_f32_32x32x16_bf16 v[60:75], v[32:35], v[16:19], 0
    ds_read_b128 v[32:35], v0 offset:2048
    v_exp_f32 v49, v49
    v_exp_f32 v50, v50
    v_exp_f32 v51, v51
    v_exp_f32 v52, v52
    v_exp_f32 v53, v53
    v_smfmac_f32_32x32x32_bf16 v[116:131], v[36:39], v[44:51], v3
    v_exp_f32 v54, v54
    v_exp_f32 v55, v55
    v_exp_f32 v56, v56
    v_exp_f32 v57, v57
    v_exp_f32 v58, v58
    v_exp_f32 v59, v59
    v_exp_f32 v60, v60
    v_exp_f32 v61, v61
    v_smfmac_f32_32x32x32_bf16 v[116:131], v[40:43], v[52:59], v3
    v_exp_f32 v62, v62
    v_exp_f32 v63, v63
    v_exp_f32 v64, v64
    v_mfma_f32_32x32x16_bf16 v[44:59], v[148:151], v[4:7], 0
    v_exp_f32 v65, v65
    v_exp_f32 v66, v66
    v_exp_f32 v67, v67
    v_exp_f32 v68, v68
    v_exp_f32 v69, v69
    v_smfmac_f32_32x32x32_bf16 v[132:147], v[36:39], v[60:67], v3
    v_exp_f32 v70, v70
    v_exp_f32 v71, v71
    v_exp_f32 v72, v72
    v_exp_f32 v73, v73
    v_exp_f32 v74, v74
    v_exp_f32 v75, v75
    v_exp_f32 v44, v44
    v_exp_f32 v45, v45
    v_smfmac_f32_32x32x32_bf16 v[132:147], v[40:43], v[68:75], v3
    s_mov_b64 exec, s[62:63]
    ds_read_b128 v[36:39], v152 offset:3072
    ds_read_b128 v[40:43], v152 offset:3584
    s_mov_b64 exec, -1
    v_exp_f32 v46, v46
    v_exp_f32 v47, v47
    v_exp_f32 v48, v48
    v_mfma_f32_32x32x16_bf16 v[60:75], v[148:151], v[8:11], 0
    v_exp_f32 v49, v49
    v_exp_f32 v50, v50
    v_exp_f32 v51, v51
    v_exp_f32 v52, v52
    v_exp_f32 v53, v53
    v_smfmac_f32_32x32x32_bf16 v[84:99], v[76:79], v[44:51], v3
    s_cbranch_vccnz L_np
    s_setprio 0
L_np:
    v_exp_f32 v54, v54
    v_exp_f32 v55, v55
    v_exp_f32 v56, v56
    v_exp_f32 v57, v57
    v_exp_f32 v58, v58
    v_exp_f32 v59, v59
    v_exp_f32 v60, v60
    v_exp_f32 v61, v61
    v_smfmac_f32_32x32x32_bf16 v[84:99], v[80:83], v[52:59], v3
    v_exp_f32 v62, v62
    v_exp_f32 v63, v63
    v_exp_f32 v64, v64
    v_mfma_f32_32x32x16_bf16 v[44:59], v[148:151], v[12:15], 0
    v_exp_f32 v65, v65
    v_exp_f32 v66, v66
    v_exp_f32 v67, v67
    v_exp_f32 v68, v68
    v_exp_f32 v69, v69
    v_smfmac_f32_32x32x32_bf16 v[100:115], v[76:79], v[60:67], v3
    v_exp_f32 v70, v70
    v_exp_f32 v71, v71
    v_exp_f32 v72, v72
    v_exp_f32 v73, v73
    v_exp_f32 v74, v74
    v_exp_f32 v75, v75
    v_exp_f32 v44, v44
    v_exp_f32 v45, v45
    v_smfmac_f32_32x32x32_bf16 v[100:115], v[80:83], v[68:75], v3
    v_exp_f32 v46, v46
    v_exp_f32 v47, v47
    v_exp_f32 v48, v48
    v_mfma_f32_32x32x16_bf16 v[60:75], v[148:151], v[16:19], 0
    ds_read_b128 v[148:151], v0 offset:4096
    v_exp_f32 v49, v49
    v_exp_f32 v50, v50
    v_exp_f32 v51, v51
    v_exp_f32 v52, v52
    v_exp_f32 v53, v53
    v_smfmac_f32_32x32x32_bf16 v[116:131], v[76:79], v[44:51], v3
    s_setprio 0
    v_exp_f32 v54, v54
    v_exp_f32 v55, v55
    v_exp_f32 v56, v56
    v_exp_f32 v57, v57
    v_exp_f32 v58, v58
    v_exp_f32 v59, v59
    v_exp_f32 v60, v60
    v_exp_f32 v61, v61
    v_smfmac_f32_32x32x32_bf16 v[116:131], v[80:83], v[52:59], v3
    s_waitcnt lgkmcnt(4)
    v_exp_f32 v62, v62
    v_exp_f32 v63, v63
    v_exp_f32 v64, v64
    v_mfma_f32_32x32x16_bf16 v[44:59], v[20:23], v[4:7], 0
    v_exp_f32 v65, v65
    v_exp_f32 v66, v66
    v_exp_f32 v67, v67
    v_exp_f32 v68, v68
    v_exp_f32 v69, v69
    v_smfmac_f32_32x32x32_bf16 v[132:147], v[76:79], v[60:67], v3
    v_exp_f32 v70, v70
    v_exp_f32 v71, v71
    v_exp_f32 v72, v72
    v_exp_f32 v73, v73
    v_exp_f32 v74, v74
    v_exp_f32 v75, v75
    v_exp_f32 v44, v44
    v_exp_f32 v45, v45
    v_smfmac_f32_32x32x32_bf16 v[132:147], v[80:83], v[68:75], v3
    s_mov_b64 exec, s[62:63]
    ds_read_b128 v[76:79], v152 offset:5120
    ds_read_b128 v[80:83], v152 offset:5632
    s_mov_b64 exec, -1
    v_exp_f32 v46, v46
    v_exp_f32 v47, v47
    v_exp_f32 v48, v48
    v_mfma_f32_32x32x16_bf16 v[60:75], v[20:23], v[8:11], 0
    v_exp_f32 v49, v49
    v_exp_f32 v50, v50
    v_exp_f32 v51, v51
    v_exp_f32 v52, v52
    v_exp_f32 v53, v53
    v_smfmac_f32_32x32x32_bf16 v[84:99], v[24:27], v[44:51], v3
    v_exp_f32 v54, v54
    v_exp_f32 v55, v55
    v_exp_f32 v56, v56
    v_exp_f32 v57, v57
    v_exp_f32 v58, v58
    v_exp_f32 v59, v59
    v_exp_f32 v60, v60
    v_exp_f32 v61, v61
    v_smfmac_f32_32x32x32_bf16 v[84:99], v[28:31], v[52:59], v3
    v_exp_f32 v62, v62
    v_exp_f32 v63, v63
    v_exp_f32 v64, v64
    v_mfma_f32_32x32x16_bf16 v[44:59], v[20:23], v[12:15], 0
    v_exp_f32 v65, v65
    v_exp_f32 v66, v66
    v_exp_f32 v67, v67
    v_exp_f32 v68, v68
    v_exp_f32 v69, v69
    v_smfmac_f32_32x32x32_bf16 v[100:115], v[24:27], v[60:67], v3
    v_exp_f32 v70, v70
    v_exp_f32 v71, v71
    v_exp_f32 v72, v72
    v_exp_f32 v73, v73
    v_exp_f32 v74, v74
    v_exp_f32 v75, v75
    v_exp_f32 v44, v44
    v_exp_f32 v45, v45
    v_smfmac_f32_32x32x32_bf16 v[100:115], v[28:31], v[68:75], v3
    v_exp_f32 v46, v46
    v_exp_f32 v47, v47
    v_exp_f32 v48, v48
    v_mfma_f32_32x32x16_bf16 v[60:75], v[20:23], v[16:19], 0
    ds_read_b128 v[20:23], v0 offset:6144
    v_exp_f32 v49, v49
    v_exp_f32 v50, v50
    v_exp_f32 v51, v51
    v_exp_f32 v52, v52
    v_exp_f32 v53, v53
    v_smfmac_f32_32x32x32_bf16 v[116:131], v[24:27], v[44:51], v3
    v_exp_f32 v54, v54
    v_exp_f32 v55, v55
    v_exp_f32 v56, v56
    v_exp_f32 v57, v57
    v_exp_f32 v58, v58
    v_exp_f32 v59, v59
    v_exp_f32 v60, v60
    v_exp_f32 v61, v61
    v_smfmac_f32_32x32x32_bf16 v[116:131], v[28:31], v[52:59], v3
    s_waitcnt lgkmcnt(4)
    v_exp_f32 v62, v62
    v_exp_f32 v63, v63
    v_exp_f32 v64, v64
    v_mfma_f32_32x32x16_bf16 v[44:59], v[32:35], v[4:7], 0
    v_exp_f32 v65, v65
    v_exp_f32 v66, v66
    v_exp_f32 v67, v67
    v_exp_f32 v68, v68
    v_exp_f32 v69, v69
    v_smfmac_f32_32x32x32_bf16 v[132:147], v[24:27], v[60:67], v3
    v_exp_f32 v70, v70
    v_exp_f32 v71, v71
    v_exp_f32 v72, v72
    v_exp_f32 v73, v73
    v_exp_f32 v74, v74
    v_exp_f32 v75, v75
    v_exp_f32 v44, v44
    v_exp_f32 v45, v45
    v_smfmac_f32_32x32x32_bf16 v[132:147], v[28:31], v[68:75], v3
    s_mov_b64 exec, s[62:63]
    ds_read_b128 v[24:27], v152 offset:7168
    ds_read_b128 v[28:31], v152 offset:7680
    s_mov_b64 exec, -1
    v_exp_f32 v46, v46
    v_exp_f32 v47, v47
    v_exp_f32 v48, v48
    v_mfma_f32_32x32x16_bf16 v[60:75], v[32:35], v[8:11], 0
    s_mov_b64 exec, 1
    ds_add_u32 v153, v154 offset:140
    s_mov_b64 exec, -1
    v_exp_f32 v49, v49
    v_exp_f32 v50, v50
    v_exp_f32 v51, v51
    v_exp_f32 v52, v52
    v_exp_f32 v53, v53
    v_smfmac_f32_32x32x32_bf16 v[84:99], v[36:39], v[44:51], v3
    v_exp_f32 v54, v54
    v_exp_f32 v55, v55
    v_exp_f32 v56, v56
    v_exp_f32 v57, v57
    v_exp_f32 v58, v58
    v_exp_f32 v59, v59
    v_exp_f32 v60, v60
    v_exp_f32 v61, v61
    v_smfmac_f32_32x32x32_bf16 v[84:99], v[40:43], v[52:59], v3
    v_exp_f32 v62, v62
    v_exp_f32 v63, v63
    v_exp_f32 v64, v64
    v_mfma_f32_32x32x16_bf16 v[44:59], v[32:35], v[12:15], 0
    v_exp_f32 v65, v65
    v_exp_f32 v66, v66
    v_exp_f32 v67, v67
    v_exp_f32 v68, v68
    v_exp_f32 v69, v69
    v_smfmac_f32_32x32x32_bf16 v[100:115], v[36:39], v[60:67], v3
    v_exp_f32 v70, v70
    v_exp_f32 v71, v71
    v_exp_f32 v72, v72
    v_exp_f32 v73, v73
    v_exp_f32 v74, v74
    v_exp_f32 v75, v75
    v_exp_f32 v44, v44
    v_exp_f32 v45, v45
    v_smfmac_f32_32x32x32_bf16 v[100:115], v[40:43], v[68:75], v3
    v_exp_f32 v46, v46
    v_exp_f32 v47, v47
    v_exp_f32 v48, v48
    v_mfma_f32_32x32x16_bf16 v[60:75], v[32:35], v[16:19], 0
    v_exp_f32 v49, v49
    v_exp_f32 v50, v50
    v_exp_f32 v51, v51
    v_exp_f32 v52, v52
    v_exp_f32 v53, v53
    v_smfmac_f32_32x32x32_bf16 v[116:131], v[36:39], v[44:51], v3
    s_mov_b64 exec, 1
    ds_add_u32 v153, v154 offset:8
    s_mov_b64 exec, -1
    v_exp_f32 v54, v54
    v_exp_f32 v55, v55
    v_exp_f32 v56, v56
    v_exp_f32 v57, v57
    v_exp_f32 v58, v58
    v_exp_f32 v59, v59
    v_exp_f32 v60, v60
    v_exp_f32 v61, v61
    v_smfmac_f32_32x32x32_bf16 v[116:131], v[40:43], v[52:59], v3
    s_waitcnt lgkmcnt(5)
    v_exp_f32 v62, v62
    v_exp_f32 v63, v63
    v_exp_f32 v64, v64
    v_mfma_f32_32x32x16_bf16 v[44:59], v[148:151], v[4:7], 0
    v_exp_f32 v65, v65
    v_exp_f32 v66, v66
    v_exp_f32 v67, v67
    v_exp_f32 v68, v68
    v_exp_f32 v69, v69
    v_smfmac_f32_32x32x32_bf16 v[132:147], v[36:39], v[60:67], v3
    v_exp_f32 v70, v70
    v_exp_f32 v71, v71
    v_exp_f32 v72, v72
    v_exp_f32 v73, v73
    v_exp_f32 v74, v74
    v_exp_f32 v75, v75
    v_exp_f32 v44, v44
    v_exp_f32 v45, v45
    v_smfmac_f32_32x32x32_bf16 v[132:147], v[40:43], v[68:75], v3
    v_exp_f32 v46, v46
    v_exp_f32 v47, v47
    v_exp_f32 v48, v48
    v_mfma_f32_32x32x16_bf16 v[60:75], v[148:151], v[8:11], 0
    v_exp_f32 v49, v49
    v_exp_f32 v50, v50
    v_exp_f32 v51, v51
    v_exp_f32 v52, v52
    v_exp_f32 v53, v53
    v_smfmac_f32_32x32x32_bf16 v[84:99], v[76:79], v[44:51], v3
    v_exp_f32 v54, v54
    v_exp_f32 v55, v55
    v_exp_f32 v56, v56
    v_exp_f32 v57, v57
    v_exp_f32 v58, v58
    v_exp_f32 v59, v59
    v_exp_f32 v60, v60
    v_exp_f32 v61, v61
    v_smfmac_f32_32x32x32_bf16 v[84:99], v[80:83], v[52:59], v3
    v_exp_f32 v62, v62
    v_exp_f32 v63, v63
    v_exp_f32 v64, v64
    v_mfma_f32_32x32x16_bf16 v[44:59], v[148:151], v[12:15], 0
    v_exp_f32 v65, v65
    v_exp_f32 v66, v66
    v_exp_f32 v67, v67
    v_exp_f32 v68, v68
    v_exp_f32 v69, v69
    v_smfmac_f32_32x32x32_bf16 v[100:115], v[76:79], v[60:67], v3
    v_exp_f32 v70, v70
    v_exp_f32 v71, v71
    v_exp_f32 v72, v72
    v_exp_f32 v73, v73
    v_exp_f32 v74, v74
    v_exp_f32 v75, v75
    v_exp_f32 v44, v44
    v_exp_f32 v45, v45
    v_smfmac_f32_32x32x32_bf16 v[100:115], v[80:83], v[68:75], v3
    s_waitcnt lgkmcnt(2)
    v_exp_f32 v46, v46
    v_exp_f32 v47, v47
    v_exp_f32 v48, v48
    v_mfma_f32_32x32x16_bf16 v[60:75], v[20:23], v[4:7], 0
    v_exp_f32 v49, v49
    v_exp_f32 v50, v50
    v_exp_f32 v51, v51
    v_exp_f32 v52, v52
    v_exp_f32 v53, v53
    v_smfmac_f32_32x32x32_bf16 v[116:131], v[76:79], v[44:51], v3
    v_exp_f32 v54, v54
    v_exp_f32 v55, v55
    v_exp_f32 v56, v56
    v_exp_f32 v57, v57
    v_exp_f32 v58, v58
    v_exp_f32 v59, v59
    v_exp_f32 v60, v60
    v_exp_f32 v61, v61
    v_smfmac_f32_32x32x32_bf16 v[116:131], v[80:83], v[52:59], v3
    ds_read_b32 v152, v153 offset:4
    v_exp_f32 v62, v62
    v_exp_f32 v63, v63
    v_exp_f32 v64, v64
    v_mfma_f32_32x32x16_bf16 v[44:59], v[20:23], v[8:11], 0
    v_exp_f32 v65, v65
    v_exp_f32 v66, v66
    v_exp_f32 v67, v67
    v_exp_f32 v68, v68
    v_exp_f32 v69, v69
    v_smfmac_f32_32x32x32_bf16 v[84:99], v[24:27], v[60:67], v3
    v_exp_f32 v70, v70
    v_exp_f32 v71, v71
    v_exp_f32 v72, v72
    v_exp_f32 v73, v73
    v_exp_f32 v74, v74
    v_exp_f32 v75, v75
    v_exp_f32 v44, v44
    v_exp_f32 v45, v45
    v_smfmac_f32_32x32x32_bf16 v[84:99], v[28:31], v[68:75], v3
    s_waitcnt lgkmcnt(0)
    v_readfirstlane_b32 s12, v152
    v_exp_f32 v46, v46
    v_exp_f32 v47, v47
    v_exp_f32 v48, v48
    v_mfma_f32_32x32x16_bf16 v[60:75], v[20:23], v[12:15], 0
    s_cmp_lt_u32 s12, s93
    s_cbranch_scc1 L_gate
L_gate_ok:
    v_exp_f32 v49, v49
    v_exp_f32 v50, v50
    v_exp_f32 v51, v51
    v_exp_f32 v52, v52
    v_exp_f32 v53, v53
    v_smfmac_f32_32x32x32_bf16 v[100:115], v[24:27], v[44:51], v3
    v_exp_f32 v54, v54
    v_exp_f32 v55, v55
    v_exp_f32 v56, v56
    v_exp_f32 v57, v57
    v_exp_f32 v58, v58
    v_exp_f32 v59, v59
    v_exp_f32 v60, v60
    v_exp_f32 v61, v61
    v_smfmac_f32_32x32x32_bf16 v[100:115], v[28:31], v[52:59], v3
    ds_write_b128 v156, v[84:87] offset:0
    v_exp_f32 v62, v62
    v_exp_f32 v63, v63
    v_exp_f32 v64, v64
    v_mfma_f32_32x32x16_bf16 v[44:59], v[148:151], v[16:19], 0
    ds_write_b128 v156, v[88:91] offset:1024
    v_exp_f32 v65, v65
    v_exp_f32 v66, v66
    v_exp_f32 v67, v67
    v_exp_f32 v68, v68
    v_exp_f32 v69, v69
    v_smfmac_f32_32x32x32_bf16 v[116:131], v[24:27], v[60:67], v3
    ds_write_b32 v157, v92 offset:2048
    v_exp_f32 v70, v70
    v_exp_f32 v71, v71
    v_exp_f32 v72, v72
    v_exp_f32 v73, v73
    v_exp_f32 v74, v74
    v_exp_f32 v75, v75
    v_exp_f32 v44, v44
    v_exp_f32 v45, v45
    v_smfmac_f32_32x32x32_bf16 v[116:131], v[28:31], v[68:75], v3
    ds_write_b128 v158, v[100:103] offset:0
    v_exp_f32 v46, v46
    v_exp_f32 v47, v47
    v_exp_f32 v48, v48
    v_mfma_f32_32x32x16_bf16 v[60:75], v[20:23], v[16:19], 0
    ds_write_b128 v158, v[104:107] offset:1024
    v_exp_f32 v49, v49
    v_exp_f32 v50, v50
    v_exp_f32 v51, v51
    v_exp_f32 v52, v52
    v_exp_f32 v53, v53
    v_smfmac_f32_32x32x32_bf16 v[132:147], v[76:79], v[44:51], v3
    ds_write_b32 v159, v108 offset:2048
    v_exp_f32 v54, v54
    v_exp_f32 v55, v55
    v_exp_f32 v56, v56
    v_exp_f32 v57, v57
    v_exp_f32 v58, v58
    v_exp_f32 v59, v59
    v_exp_f32 v60, v60
    v_exp_f32 v61, v61
    v_smfmac_f32_32x32x32_bf16 v[132:147], v[80:83], v[52:59], v3
    ds_write_b128 v160, v[116:119] offset:0
    ds_write_b128 v160, v[120:123] offset:1024
    ds_write_b32 v161, v124 offset:2048
    s_mov_b64 exec, 1
    ds_add_u32 v155, v154 offset:32
    s_mov_b64 exec, -1
    v_exp_f32 v62, v62
    v_exp_f32 v63, v63
    v_exp_f32 v64, v64
    v_exp_f32 v65, v65
    v_exp_f32 v66, v66
    v_exp_f32 v67, v67
    v_exp_f32 v68, v68
    v_exp_f32 v69, v69
    v_smfmac_f32_32x32x32_bf16 v[132:147], v[24:27], v[60:67], v3
    v_exp_f32 v70, v70
    v_exp_f32 v71, v71
    v_exp_f32 v72, v72
    v_exp_f32 v73, v73
    v_exp_f32 v74, v74
    v_exp_f32 v75, v75
    s_setprio 3
    s_mov_b32 s59, 4
    v_smfmac_f32_32x32x32_bf16 v[132:147], v[28:31], v[68:75], v3
    s_mov_b32 s58, 0
L_A_fin:
    s_mov_b32 s61, 800000
L_A_fs:
    ds_read_b32 v152, v155 offset:32
    ds_read_b128 v[84:87], v162 offset:0
    ds_read_b128 v[88:91], v162 offset:1024
    ds_read_b32 v92, v163 offset:2048
    ds_read_b128 v[100:103], v162 offset:2304
    ds_read_b128 v[104:107], v162 offset:3328
    ds_read_b32 v108, v163 offset:4352
    ds_read_b128 v[116:119], v162 offset:4608
    ds_read_b128 v[120:123], v162 offset:5632
    ds_read_b32 v124, v163 offset:6656
    s_waitcnt lgkmcnt(9)
    v_readfirstlane_b32 s12, v152
    s_nop 0
    s_cmp_lt_u32 s12, s59
    s_cbranch_scc1 L_A_fw
L_A_go:
    s_waitcnt lgkmcnt(6)
    v_add_f32 v140, v140, v92
    v_pk_add_f32 v[132:133], v[132:133], v[84:85]
    v_pk_add_f32 v[134:135], v[134:135], v[86:87]
    v_pk_add_f32 v[136:137], v[136:137], v[88:89]
    v_pk_add_f32 v[138:139], v[138:139], v[90:91]
    s_waitcnt lgkmcnt(3)
    v_add_f32 v140, v140, v108
    v_pk_add_f32 v[132:133], v[132:133], v[100:101]
    v_pk_add_f32 v[134:135], v[134:135], v[102:103]
    v_pk_add_f32 v[136:137], v[136:137], v[104:105]
    v_pk_add_f32 v[138:139], v[138:139], v[106:107]
    s_waitcnt lgkmcnt(0)
    v_add_f32 v140, v140, v124
    v_rcp_f32 v142, v140
    v_pk_add_f32 v[132:133], v[132:133], v[116:117]
    v_pk_add_f32 v[134:135], v[134:135], v[118:119]
    v_pk_add_f32 v[136:137], v[136:137], v[120:121]
    v_pk_add_f32 v[138:139], v[138:139], v[122:123]
    v_cmp_le_f32 vcc, 0x30800000, v140
    v_pk_mul_f32 v[132:133], v[132:133], v[142:143] op_sel_hi:[1,0]
    v_pk_mul_f32 v[134:135], v[134:135], v[142:143] op_sel_hi:[1,0]
    v_pk_mul_f32 v[136:137], v[136:137], v[142:143] op_sel_hi:[1,0]
    v_pk_mul_f32 v[138:139], v[138:139], v[142:143] op_sel_hi:[1,0]
    s_mov_b64 s[14:15], vcc
    v_cmp_ge_f32 vcc, 0x56000000, v140
    v_cvt_pk_bf16_f32 v20, v132, v133
    v_cvt_pk_bf16_f32 v21, v134, v135
    v_cvt_pk_bf16_f32 v22, v136, v137
    v_cvt_pk_bf16_f32 v23, v138, v139
    s_and_b64 vcc, vcc, s[14:15]
    s_cmp_lg_u32 s58, 0
    s_cbranch_scc1 L_A_fin2
    s_cmp_eq_u64 vcc, -1
    s_cselect_b32 s58, 2, 1
    s_cbranch_scc0 L_A_bad
    buffer_store_dwordx4 v[20:23], v1, s[8:11], s60 offen sc1
    s_mov_b64 exec, 1
    ds_add_u32 v155, v154 offset:40
    s_mov_b64 exec, -1
L_A_nst:
    s_cmp_lt_u32 s3, 4
    s_cbranch_scc1 L_A_nb
    s_waitcnt lgkmcnt(0)
    s_barrier
L_A_nb:
    s_mov_b32 s61, 800000
L_pb:
    ds_read_b32 v152, v155 offset:40
    s_waitcnt lgkmcnt(0)
    v_readfirstlane_b32 s12, v152
    s_nop 1
    s_and_b32 s12, s12, 255
    s_cmp_ge_u32 s12, 4
    s_cbranch_scc1 L_pb_ok
    s_sleep 2
    s_sub_u32 s61, s61, 1
    s_cmp_lg_u32 s61, 0
    s_cbranch_scc1 L_pb
L_pb_ok:
    v_readfirstlane_b32 s12, v152
    s_nop 1
    s_lshr_b32 s12, s12, 8
    s_cbranch_scc1 L_A_fb
L_F:
    s_mov_b64 exec, 1
    ds_add_u32 v153, v154 offset:4
    s_mov_b64 exec, -1
    v_xor_b32 v149, 32, v166
    v_xor_b32 v150, 64, v166
    v_xor_b32 v151, 96, v166
    ds_read_b64_tr_b16 v[52:53], v166 offset:0
    ds_read_b64_tr_b16 v[54:55], v166 offset:1024
    ds_read_b64_tr_b16 v[56:57], v149 offset:0
    ds_read_b64_tr_b16 v[58:59], v149 offset:1024
    ds_read_b64_tr_b16 v[60:61], v150 offset:0
    ds_read_b64_tr_b16 v[62:63], v150 offset:1024
    ds_read_b64_tr_b16 v[64:65], v151 offset:0
    ds_read_b64_tr_b16 v[66:67], v151 offset:1024
    ds_read_b64_tr_b16 v[68:69], v166 offset:8192
    ds_read_b64_tr_b16 v[70:71], v166 offset:9216
    ds_read_b64_tr_b16 v[72:73], v149 offset:8192
    ds_read_b64_tr_b16 v[74:75], v149 offset:9216
    ds_read_b64_tr_b16 v[76:77], v150 offset:8192
    ds_read_b64_tr_b16 v[78:79], v150 offset:9216
    ds_read_b64_tr_b16 v[80:81], v151 offset:8192
    ds_read_b64_tr_b16 v[82:83], v151 offset:9216
    ds_read_b64_tr_b16 v[84:85], v166 offset:16384
    ds_read_b64_tr_b16 v[86:87], v166 offset:17408
    ds_read_b64_tr_b16 v[88:89], v149 offset:16384
    ds_read_b64_tr_b16 v[90:91], v149 offset:17408
    ds_read_b64_tr_b16 v[92:93], v150 offset:16384
    ds_read_b64_tr_b16 v[94:95], v150 offset:17408
    ds_read_b64_tr_b16 v[96:97], v151 offset:16384
    ds_read_b64_tr_b16 v[98:99], v151 offset:17408
    ds_read_b64_tr_b16 v[100:101], v166 offset:24576
    ds_read_b64_tr_b16 v[102:103], v166 offset:25600
    ds_read_b64_tr_b16 v[104:105], v149 offset:24576
    ds_read_b64_tr_b16 v[106:107], v149 offset:25600
    ds_read_b64_tr_b16 v[108:109], v150 offset:24576
    ds_read_b64_tr_b16 v[110:111], v150 offset:25600
    ds_read_b64_tr_b16 v[112:113], v151 offset:24576
    ds_read_b64_tr_b16 v[114:115], v151 offset:25600
    v_xor_b32 v166, 0x8000, v166
    v_xor_b32 v149, 0x8000, v149
    v_xor_b32 v150, 0x8000, v150
    v_xor_b32 v151, 0x8000, v151
    ds_read_b64_tr_b16 v[116:117], v166 offset:0
    ds_read_b64_tr_b16 v[118:119], v166 offset:1024
    ds_read_b64_tr_b16 v[120:121], v149 offset:0
    ds_read_b64_tr_b16 v[122:123], v149 offset:1024
    ds_read_b64_tr_b16 v[124:125], v150 offset:0
    ds_read_b64_tr_b16 v[126:127], v150 offset:1024
    ds_read_b64_tr_b16 v[128:129], v151 offset:0
    ds_read_b64_tr_b16 v[130:131], v151 offset:1024
    ds_read_b64_tr_b16 v[132:133], v166 offset:8192
    ds_read_b64_tr_b16 v[134:135], v166 offset:9216
    ds_read_b64_tr_b16 v[136:137], v149 offset:8192
    ds_read_b64_tr_b16 v[138:139], v149 offset:9216
    ds_read_b64_tr_b16 v[140:141], v150 offset:8192
    ds_read_b64_tr_b16 v[142:143], v150 offset:9216
    ds_read_b64_tr_b16 v[144:145], v151 offset:8192
    ds_read_b64_tr_b16 v[146:147], v151 offset:9216
    s_waitcnt lgkmcnt(0)
    s_mov_b32 s15, 200000
    s_cmp_lt_u32 s3, 4
    s_cbranch_scc1 L_F_f0
L_F_y0:
    s_waitcnt vmcnt(0)
L_F_y2:
    s_add_u32 s12, s94, 0
    buffer_load_dwordx4 v[4:7], v164, s[8:11], s12 offen sc1
    s_add_u32 s12, s94, 8192
    buffer_load_dwordx4 v[8:11], v164, s[8:11], s12 offen sc1
    s_add_u32 s12, s94, 16384
    buffer_load_dwordx4 v[12:15], v164, s[8:11], s12 offen sc1
    s_add_u32 s12, s94, 24576
    buffer_load_dwordx4 v[16:19], v164, s[8:11], s12 offen sc1
    s_add_u32 s12, s95, 0
    buffer_load_dwordx4 v[20:23], v164, s[8:11], s12 offen sc1
    s_add_u32 s12, s95, 8192
    buffer_load_dwordx4 v[24:27], v164, s[8:11], s12 offen sc1
    s_add_u32 s12, s95, 16384
    buffer_load_dwordx4 v[28:31], v164, s[8:11], s12 offen sc1
    s_add_u32 s12, s95, 24576
    buffer_load_dwordx4 v[32:35], v164, s[8:11], s12 offen sc1
    s_cmp_lt_u32 s3, 4
    s_cbranch_scc0 L_F_y1
    s_setprio 2
    s_barrier
L_F_y1:
    s_lshl_b32 s13, s92, 3
    v_add_u32 v155, s13, v153
    v_add_u32 v156, 65536, v167
L_o_chk0:
    s_waitcnt vmcnt(7)
    v_max3_u32 v148, v4, v4, v5
    v_max3_u32 v148, v148, v6, v7
    s_waitcnt vmcnt(6)
    v_max3_u32 v148, v148, v8, v9
    v_max3_u32 v148, v148, v10, v11
    s_waitcnt vmcnt(5)
    v_max3_u32 v148, v148, v12, v13
    v_max3_u32 v148, v148, v14, v15
    s_waitcnt vmcnt(4)
    v_max3_u32 v148, v148, v16, v17
    v_max3_u32 v148, v148, v18, v19
    v_cmp_eq_u32 vcc, -1, v148
    s_waitcnt lgkmcnt(0)
    s_cmp_lg_u64 vcc, 0
    s_cbranch_scc1 L_o_again0
L_o_go0:
    v_mfma_f32_16x16x32_bf16 v[36:39], v[52:55], v[4:7], 0
    ds_read_b64_tr_b16 v[52:53], v166 offset:16384
    ds_read_b64_tr_b16 v[54:55], v166 offset:17408
    v_mfma_f32_16x16x32_bf16 v[40:43], v[56:59], v[4:7], 0
    ds_read_b64_tr_b16 v[56:57], v149 offset:16384
    ds_read_b64_tr_b16 v[58:59], v149 offset:17408
    v_mfma_f32_16x16x32_bf16 v[44:47], v[60:63], v[4:7], 0
    ds_read_b64_tr_b16 v[60:61], v150 offset:16384
    ds_read_b64_tr_b16 v[62:63], v150 offset:17408
    v_mfma_f32_16x16x32_bf16 v[48:51], v[64:67], v[4:7], 0
    ds_read_b64_tr_b16 v[64:65], v151 offset:16384
    ds_read_b64_tr_b16 v[66:67], v151 offset:17408
    v_mfma_f32_16x16x32_bf16 v[36:39], v[68:71], v[8:11], v[36:39]
    ds_read_b64_tr_b16 v[68:69], v166 offset:24576
    ds_read_b64_tr_b16 v[70:71], v166 offset:25600
    v_mfma_f32_16x16x32_bf16 v[40:43], v[72:75], v[8:11], v[40:43]
    ds_read_b64_tr_b16 v[72:73], v149 offset:24576
    ds_read_b64_tr_b16 v[74:75], v149 offset:25600
    v_mfma_f32_16x16x32_bf16 v[44:47], v[76:79], v[8:11], v[44:47]
    ds_read_b64_tr_b16 v[76:77], v150 offset:24576
    ds_read_b64_tr_b16 v[78:79], v150 offset:25600
    v_mfma_f32_16x16x32_bf16 v[48:51], v[80:83], v[8:11], v[48:51]
    ds_read_b64_tr_b16 v[80:81], v151 offset:24576
    ds_read_b64_tr_b16 v[82:83], v151 offset:25600
    v_mfma_f32_16x16x32_bf16 v[36:39], v[84:87], v[12:15], v[36:39]
    v_mfma_f32_16x16x32_bf16 v[40:43], v[88:91], v[12:15], v[40:43]
    v_mfma_f32_16x16x32_bf16 v[44:47], v[92:95], v[12:15], v[44:47]
    v_mfma_f32_16x16x32_bf16 v[48:51], v[96:99], v[12:15], v[48:51]
    v_mfma_f32_16x16x32_bf16 v[36:39], v[100:103], v[16:19], v[36:39]
    v_mfma_f32_16x16x32_bf16 v[40:43], v[104:107], v[16:19], v[40:43]
    v_mfma_f32_16x16x32_bf16 v[44:47], v[108:111], v[16:19], v[44:47]
    v_mfma_f32_16x16x32_bf16 v[48:51], v[112:115], v[16:19], v[48:51]
L_o_chk1:
    s_waitcnt vmcnt(3)
    v_max3_u32 v148, v20, v20, v21
    v_max3_u32 v148, v148, v22, v23
    s_waitcnt vmcnt(2)
    v_max3_u32 v148, v148, v24, v25
    v_max3_u32 v148, v148, v26, v27
    s_waitcnt vmcnt(1)
    v_max3_u32 v148, v148, v28, v29
    v_max3_u32 v148, v148, v30, v31
    s_waitcnt vmcnt(0)
    v_max3_u32 v148, v148, v32, v33
    v_max3_u32 v148, v148, v34, v35
    v_cmp_eq_u32 vcc, -1, v148
    s_waitcnt lgkmcnt(0)
    s_cmp_lg_u64 vcc, 0
    s_cbranch_scc1 L_o_again1
L_o_go1:
    s_cmp_lt_u32 s3, 4
    s_cbranch_scc1 L_nrf
    ds_read_b64 v[158:159], v155 offset:48
    ds_read_b128 v[4:7], v156 offset:0
    ds_read_b128 v[84:87], v167 offset:0
    ds_read_b128 v[100:103], v167 offset:16384
    ds_read_b128 v[8:11], v156 offset:1024
    ds_read_b128 v[88:91], v167 offset:1024
    ds_read_b128 v[104:107], v167 offset:17408
    ds_read_b128 v[12:15], v156 offset:2048
    ds_read_b128 v[92:95], v167 offset:2048
    ds_read_b128 v[108:111], v167 offset:18432
    ds_read_b128 v[16:19], v156 offset:3072
    ds_read_b128 v[96:99], v167 offset:3072
    ds_read_b128 v[112:115], v167 offset:19456
L_nrf:
    v_mfma_f32_16x16x32_bf16 v[36:39], v[116:119], v[20:23], v[36:39]
    v_mfma_f32_16x16x32_bf16 v[40:43], v[120:123], v[20:23], v[40:43]
    v_mfma_f32_16x16x32_bf16 v[44:47], v[124:127], v[20:23], v[44:47]
    v_mfma_f32_16x16x32_bf16 v[48:51], v[128:131], v[20:23], v[48:51]
    v_mfma_f32_16x16x32_bf16 v[36:39], v[132:135], v[24:27], v[36:39]
    v_mfma_f32_16x16x32_bf16 v[40:43], v[136:139], v[24:27], v[40:43]
    v_mfma_f32_16x16x32_bf16 v[44:47], v[140:143], v[24:27], v[44:47]
    v_mfma_f32_16x16x32_bf16 v[48:51], v[144:147], v[24:27], v[48:51]
    v_mfma_f32_16x16x32_bf16 v[36:39], v[52:55], v[28:31], v[36:39]
    v_mfma_f32_16x16x32_bf16 v[40:43], v[56:59], v[28:31], v[40:43]
    v_mfma_f32_16x16x32_bf16 v[44:47], v[60:63], v[28:31], v[44:47]
    v_mfma_f32_16x16x32_bf16 v[48:51], v[64:67], v[28:31], v[48:51]
    v_mfma_f32_16x16x32_bf16 v[36:39], v[68:71], v[32:35], v[36:39]
    v_mfma_f32_16x16x32_bf16 v[40:43], v[72:75], v[32:35], v[40:43]
    v_mfma_f32_16x16x32_bf16 v[44:47], v[76:79], v[32:35], v[44:47]
    v_mfma_f32_16x16x32_bf16 v[48:51], v[80:83], v[32:35], v[48:51]
    s_cmp_lt_u32 s3, 4
    s_cbranch_scc1 L_F_w
L_F_ck:
    s_waitcnt lgkmcnt(0)
    v_and_b32 v158, v158, v159
    s_nop 0
    v_readfirstlane_b32 s12, v158
    s_nop 0
    s_cmp_eq_u32 s12, 0
    s_cbranch_scc1 L_F_g
L_F_go:
    v_pk_add_f32 v[36:37], v[36:37], v[4:5]
    v_pk_fma_f32 v[100:101], v[36:37], v[84:85], v[100:101]
    v_cvt_pk_bf16_f32 v52, v100, v101
    v_pk_add_f32 v[38:39], v[38:39], v[6:7]
    v_pk_fma_f32 v[102:103], v[38:39], v[86:87], v[102:103]
    v_cvt_pk_bf16_f32 v53, v102, v103
    v_pk_add_f32 v[40:41], v[40:41], v[8:9]
    v_pk_fma_f32 v[104:105], v[40:41], v[88:89], v[104:105]
    v_cvt_pk_bf16_f32 v54, v104, v105
    v_pk_add_f32 v[42:43], v[42:43], v[10:11]
    v_pk_fma_f32 v[106:107], v[42:43], v[90:91], v[106:107]
    v_cvt_pk_bf16_f32 v55, v106, v107
    s_nop 0
    v_permlane32_swap_b32 v52, v54
    v_permlane32_swap_b32 v53, v55
    s_nop 0
    v_permlane16_swap_b32 v52, v54
    v_permlane16_swap_b32 v53, v55
    v_pk_add_f32 v[44:45], v[44:45], v[12:13]
    v_pk_fma_f32 v[108:109], v[44:45], v[92:93], v[108:109]
    v_cvt_pk_bf16_f32 v56, v108, v109
    v_pk_add_f32 v[46:47], v[46:47], v[14:15]
    v_pk_fma_f32 v[110:111], v[46:47], v[94:95], v[110:111]
    v_cvt_pk_bf16_f32 v57, v110, v111
    v_pk_add_f32 v[48:49], v[48:49], v[16:17]
    v_pk_fma_f32 v[112:113], v[48:49], v[96:97], v[112:113]
    v_cvt_pk_bf16_f32 v58, v112, v113
    v_pk_add_f32 v[50:51], v[50:51], v[18:19]
    v_pk_fma_f32 v[114:115], v[50:51], v[98:99], v[114:115]
    v_cvt_pk_bf16_f32 v59, v114, v115
    s_nop 0
    v_permlane32_swap_b32 v56, v58
    v_permlane32_swap_b32 v57, v59
    s_nop 0
    v_permlane16_swap_b32 v56, v58
    v_permlane16_swap_b32 v57, v59
    v_mov_b32 v60, v52
    v_mov_b32 v61, v53
    v_mov_b32 v62, v54
    v_mov_b32 v63, v55
    s_add_u32 s12, s57, 8192
    v_mov_b32_dpp v52, v56 row_ror:8 row_mask:0xf bank_mask:0xc
    v_mov_b32_dpp v53, v57 row_ror:8 row_mask:0xf bank_mask:0xc
    v_mov_b32_dpp v54, v58 row_ror:8 row_mask:0xf bank_mask:0xc
    v_mov_b32_dpp v55, v59 row_ror:8 row_mask:0xf bank_mask:0xc
    buffer_store_dwordx4 v[52:55], v165, s[48:51], s57 offen sc1
    v_mov_b32_dpp v56, v60 row_ror:8 row_mask:0xf bank_mask:0x3
    v_mov_b32_dpp v57, v61 row_ror:8 row_mask:0xf bank_mask:0x3
    v_mov_b32_dpp v58, v62 row_ror:8 row_mask:0xf bank_mask:0x3
    v_mov_b32_dpp v59, v63 row_ror:8 row_mask:0xf bank_mask:0x3
    buffer_store_dwordx4 v[56:59], v165, s[48:51], s12 offen sc1
    s_endpgm
L_o_again0:
    s_sub_u32 s15, s15, 1
    s_cbranch_scc1 L_o_up0
    s_waitcnt vmcnt(0)
    v_max3_u32 v148, v4, v5, v6
    v_max_u32 v148, v148, v7
    v_cmp_eq_u32 vcc, -1, v148
    s_add_u32 s12, s94, 0
    s_mov_b64 exec, vcc
    buffer_load_dwordx4 v[4:7], v164, s[8:11], s12 offen sc1
    s_mov_b64 exec, -1
    v_max3_u32 v148, v8, v9, v10
    v_max_u32 v148, v148, v11
    v_cmp_eq_u32 vcc, -1, v148
    s_add_u32 s12, s94, 8192
    s_mov_b64 exec, vcc
    buffer_load_dwordx4 v[8:11], v164, s[8:11], s12 offen sc1
    s_mov_b64 exec, -1
    v_max3_u32 v148, v12, v13, v14
    v_max_u32 v148, v148, v15
    v_cmp_eq_u32 vcc, -1, v148
    s_add_u32 s12, s94, 16384
    s_mov_b64 exec, vcc
    buffer_load_dwordx4 v[12:15], v164, s[8:11], s12 offen sc1
    s_mov_b64 exec, -1
    v_max3_u32 v148, v16, v17, v18
    v_max_u32 v148, v148, v19
    v_cmp_eq_u32 vcc, -1, v148
    s_add_u32 s12, s94, 24576
    s_mov_b64 exec, vcc
    buffer_load_dwordx4 v[16:19], v164, s[8:11], s12 offen sc1
    s_mov_b64 exec, -1
    v_max3_u32 v148, v20, v21, v22
    v_max_u32 v148, v148, v23
    v_cmp_eq_u32 vcc, -1, v148
    s_add_u32 s12, s95, 0
    s_mov_b64 exec, vcc
    buffer_load_dwordx4 v[20:23], v164, s[8:11], s12 offen sc1
    s_mov_b64 exec, -1
    v_max3_u32 v148, v24, v25, v26
    v_max_u32 v148, v148, v27
    v_cmp_eq_u32 vcc, -1, v148
    s_add_u32 s12, s95, 8192
    s_mov_b64 exec, vcc
    buffer_load_dwordx4 v[24:27], v164, s[8:11], s12 offen sc1
    s_mov_b64 exec, -1
    v_max3_u32 v148, v28, v29, v30
    v_max_u32 v148, v148, v31
    v_cmp_eq_u32 vcc, -1, v148
    s_add_u32 s12, s95, 16384
    s_mov_b64 exec, vcc
    buffer_load_dwordx4 v[28:31], v164, s[8:11], s12 offen sc1
    s_mov_b64 exec, -1
    v_max3_u32 v148, v32, v33, v34
    v_max_u32 v148, v148, v35
    v_cmp_eq_u32 vcc, -1, v148
    s_add_u32 s12, s95, 24576
    s_mov_b64 exec, vcc
    buffer_load_dwordx4 v[32:35], v164, s[8:11], s12 offen sc1
    s_mov_b64 exec, -1
    s_branch L_o_chk0
L_o_up0:
    s_mov_b32 s15, 0
    s_branch L_o_go0
L_o_again1:
    s_sub_u32 s15, s15, 1
    s_cbranch_scc1 L_o_up1
    s_waitcnt vmcnt(0)
    v_max3_u32 v148, v20, v21, v22
    v_max_u32 v148, v148, v23
    v_cmp_eq_u32 vcc, -1, v148
    s_add_u32 s12, s95, 0
    s_mov_b64 exec, vcc
    buffer_load_dwordx4 v[20:23], v164, s[8:11], s12 offen sc1
    s_mov_b64 exec, -1
    v_max3_u32 v148, v24, v25, v26
    v_max_u32 v148, v148, v27
    v_cmp_eq_u32 vcc, -1, v148
    s_add_u32 s12, s95, 8192
    s_mov_b64 exec, vcc
    buffer_load_dwordx4 v[24:27], v164, s[8:11], s12 offen sc1
    s_mov_b64 exec, -1
    v_max3_u32 v148, v28, v29, v30
    v_max_u32 v148, v148, v31
    v_cmp_eq_u32 vcc, -1, v148
    s_add_u32 s12, s95, 16384
    s_mov_b64 exec, vcc
    buffer_load_dwordx4 v[28:31], v164, s[8:11], s12 offen sc1
    s_mov_b64 exec, -1
    v_max3_u32 v148, v32, v33, v34
    v_max_u32 v148, v148, v35
    v_cmp_eq_u32 vcc, -1, v148
    s_add_u32 s12, s95, 24576
    s_mov_b64 exec, vcc
    buffer_load_dwordx4 v[32:35], v164, s[8:11], s12 offen sc1
    s_mov_b64 exec, -1
    s_branch L_o_chk1
L_o_up1:
    s_mov_b32 s15, 0
    s_branch L_o_go1
L_F_g:
    s_sub_u32 s15, s15, 1
    s_cbranch_scc1 L_F_go
    s_sleep 1
    ds_read_b64 v[158:159], v155 offset:48
    ds_read_b128 v[4:7], v156 offset:0
    ds_read_b128 v[84:87], v167 offset:0
    ds_read_b128 v[100:103], v167 offset:16384
    ds_read_b128 v[8:11], v156 offset:1024
    ds_read_b128 v[88:91], v167 offset:1024
    ds_read_b128 v[104:107], v167 offset:17408
    ds_read_b128 v[12:15], v156 offset:2048
    ds_read_b128 v[92:95], v167 offset:2048
    ds_read_b128 v[108:111], v167 offset:18432
    ds_read_b128 v[16:19], v156 offset:3072
    ds_read_b128 v[96:99], v167 offset:3072
    ds_read_b128 v[112:115], v167 offset:19456
    s_branch L_F_ck
L_F_f0:
    s_or_b32 s12, s2, s3
    s_cmp_lg_u32 s12, 0
    s_cbranch_scc1 L_F_ne
    v_mov_b32 v148, s6
    s_mov_b64 exec, 1
    buffer_store_dword v148, v1, s[8:11], 0 offen sc1
    s_mov_b64 exec, -1
L_F_ne:
    s_waitcnt vmcnt(0)
    s_mov_b32 s61, 800000
L_pt2:
    ds_read_b32 v152, v153 offset:8
    s_waitcnt lgkmcnt(0)
    v_readfirstlane_b32 s12, v152
    s_nop 1
    s_cmp_eq_u32 s12, 8
    s_cbranch_scc1 L_pt2_ok
    s_sleep 6
    s_sub_u32 s61, s61, 1
    s_cmp_lg_u32 s61, 0
    s_cbranch_scc1 L_pt2
L_pt2_ok:
    s_branch L_F_y2
L_F_w:
    s_mov_b32 s61, 800000
L_pw:
    ds_read_b32 v152, v153 offset:4
    s_waitcnt lgkmcnt(0)
    v_readfirstlane_b32 s12, v152
    s_nop 1
    s_cmp_ge_u32 s12, 20
    s_cbranch_scc1 L_pw_ok
    s_sleep 1
    s_sub_u32 s61, s61, 1
    s_cmp_lg_u32 s61, 0
    s_cbranch_scc1 L_pw
L_pw_ok:
    ds_write_b128 v156, v[36:39] offset:0
    ds_write_b128 v156, v[40:43] offset:1024
    ds_write_b128 v156, v[44:47] offset:2048
    ds_write_b128 v156, v[48:51] offset:3072
    ds_write_b32 v155, v154 offset:52
    s_waitcnt lgkmcnt(0)
    s_endpgm
L_kl0:
    v_mov_b32 v0, s54
    s_mov_b32 s61, 800000
L_pkl0:
    ds_read_b32 v152, v0 offset:96
    s_waitcnt lgkmcnt(0)
    v_readfirstlane_b32 s12, v152
    s_nop 1
    s_and_b32 s12, s12, 1
    s_cmp_eq_u32 s12, 1
    s_cbranch_scc1 L_pkl0_ok
    s_sleep 3
    s_sub_u32 s61, s61, 1
    s_cmp_lg_u32 s61, 0
    s_cbranch_scc1 L_pkl0
L_pkl0_ok:
    s_branch L_kl0d
L_fl1:
    s_mov_b32 s61, 800000
L_pfl1:
    ds_read_b32 v0, v153 offset:128
    s_waitcnt lgkmcnt(0)
    v_readfirstlane_b32 s12, v0
    s_nop 1
    s_cmp_eq_u32 s12, 8
    s_cbranch_scc1 L_pfl1_ok
    s_sleep 2
    s_sub_u32 s61, s61, 1
    s_cmp_lg_u32 s61, 0
    s_cbranch_scc1 L_pfl1
L_pfl1_ok:
    s_add_u32 m0, s44, 0
    s_add_u32 s12, s45, 6
    s_and_b32 s12, s12, 15
    s_lshl_b32 s12, s12, 11
    s_add_u32 s12, s12, s90
    buffer_load_dwordx4 v1, s[8:11], s12 offen sc1 lds
    buffer_load_dwordx4 v1, s[8:11], s12 offen offset:1024 sc1 lds
    s_add_u32 m0, s44, 2048
    s_add_u32 s12, s45, 7
    s_and_b32 s12, s12, 15
    s_lshl_b32 s12, s12, 11
    s_add_u32 s12, s12, s90
    buffer_load_dwordx4 v1, s[8:11], s12 offen sc1 lds
    buffer_load_dwordx4 v1, s[8:11], s12 offen offset:1024 sc1 lds
    s_add_u32 m0, s44, 4096
    s_add_u32 s12, s45, 8
    s_and_b32 s12, s12, 15
    s_lshl_b32 s12, s12, 11
    s_add_u32 s12, s12, s90
    buffer_load_dwordx4 v1, s[8:11], s12 offen sc1 lds
    buffer_load_dwordx4 v1, s[8:11], s12 offen offset:1024 sc1 lds
    s_branch L_fl1d
L_ld1:
    v_mov_b32 v0, s54
    v_mov_b32 v154, 2
    s_waitcnt vmcnt(0)
    s_mov_b64 exec, 1
    ds_add_u32 v0, v154 offset:96
    s_mov_b64 exec, -1
    v_mov_b32 v154, 1
    s_waitcnt lgkmcnt(0)
    s_branch L_ld1d
L_kl1:
    v_mov_b32 v0, s54
    s_mov_b32 s61, 800000
L_pkl1:
    ds_read_b32 v152, v0 offset:96
    s_waitcnt lgkmcnt(0)
    v_readfirstlane_b32 s12, v152
    s_nop 1
    s_and_b32 s12, s12, 2
    s_cmp_eq_u32 s12, 2
    s_cbranch_scc1 L_pkl1_ok
    s_sleep 3
    s_sub_u32 s61, s61, 1
    s_cmp_lg_u32 s61, 0
    s_cbranch_scc1 L_pkl1
L_pkl1_ok:
    s_branch L_kl1d
L_fl2:
    s_mov_b32 s61, 800000
L_pfl2:
    ds_read_b32 v0, v153 offset:132
    s_waitcnt lgkmcnt(0)
    v_readfirstlane_b32 s12, v0
    s_nop 1
    s_cmp_eq_u32 s12, 8
    s_cbranch_scc1 L_pfl2_ok
    s_sleep 2
    s_sub_u32 s61, s61, 1
    s_cmp_lg_u32 s61, 0
    s_cbranch_scc1 L_pfl2
L_pfl2_ok:
    s_add_u32 m0, s44, 0
    s_add_u32 s12, s45, 9
    s_and_b32 s12, s12, 15
    s_lshl_b32 s12, s12, 11
    s_add_u32 s12, s12, s90
    buffer_load_dwordx4 v1, s[8:11], s12 offen sc1 lds
    buffer_load_dwordx4 v1, s[8:11], s12 offen offset:1024 sc1 lds
    s_add_u32 m0, s44, 2048
    s_add_u32 s12, s45, 10
    s_and_b32 s12, s12, 15
    s_lshl_b32 s12, s12, 11
    s_add_u32 s12, s12, s90
    buffer_load_dwordx4 v1, s[8:11], s12 offen sc1 lds
    buffer_load_dwordx4 v1, s[8:11], s12 offen offset:1024 sc1 lds
    s_add_u32 m0, s44, 4096
    s_add_u32 s12, s45, 11
    s_and_b32 s12, s12, 15
    s_lshl_b32 s12, s12, 11
    s_add_u32 s12, s12, s90
    buffer_load_dwordx4 v1, s[8:11], s12 offen sc1 lds
    buffer_load_dwordx4 v1, s[8:11], s12 offen offset:1024 sc1 lds
    s_branch L_fl2d
L_ld2:
    v_mov_b32 v0, s54
    v_mov_b32 v154, 4
    s_waitcnt vmcnt(0)
    s_mov_b64 exec, 1
    ds_add_u32 v0, v154 offset:96
    s_mov_b64 exec, -1
    v_mov_b32 v154, 1
    s_waitcnt lgkmcnt(0)
    s_branch L_ld2d
L_kl2:
    v_mov_b32 v0, s54
    s_mov_b32 s61, 800000
L_pkl2:
    ds_read_b32 v152, v0 offset:96
    s_waitcnt lgkmcnt(0)
    v_readfirstlane_b32 s12, v152
    s_nop 1
    s_and_b32 s12, s12, 4
    s_cmp_eq_u32 s12, 4
    s_cbranch_scc1 L_pkl2_ok
    s_sleep 3
    s_sub_u32 s61, s61, 1
    s_cmp_lg_u32 s61, 0
    s_cbranch_scc1 L_pkl2
L_pkl2_ok:
    s_branch L_kl2d
L_kl3:
    v_mov_b32 v0, s54
    s_mov_b32 s61, 800000
L_pkl3:
    ds_read_b32 v152, v0 offset:96
    s_waitcnt lgkmcnt(0)
    v_readfirstlane_b32 s12, v152
    s_nop 1
    s_and_b32 s12, s12, 8
    s_cmp_eq_u32 s12, 8
    s_cbranch_scc1 L_pkl3_ok
    s_sleep 3
    s_sub_u32 s61, s61, 1
    s_cmp_lg_u32 s61, 0
    s_cbranch_scc1 L_pkl3
L_pkl3_ok:
    s_branch L_kl3d
L_gate:
    s_mov_b32 s61, 800000
L_pg:
    ds_read_b32 v152, v153 offset:4
    s_waitcnt lgkmcnt(0)
    v_readfirstlane_b32 s12, v152
    s_nop 1
    s_cmp_ge_u32 s12, s93
    s_cbranch_scc1 L_pg_ok
    s_sleep 2
    s_sub_u32 s61, s61, 1
    s_cmp_lg_u32 s61, 0
    s_cbranch_scc1 L_pg
L_pg_ok:
    s_branch L_gate_ok
L_A_fw:
    s_sub_u32 s61, s61, 1
    s_cbranch_scc1 L_A_go
    s_cmp_ge_u32 s3, 4
    s_cbranch_scc1 L_A_fs
    s_sleep 3
    s_branch L_A_fs
L_A_bad:
    v_mov_b32 v152, 0x101
    s_mov_b64 exec, 1
    ds_add_u32 v155, v152 offset:40
    s_mov_b64 exec, -1
    s_branch L_A_nst
L_A_fin2:
    s_cmp_eq_u32 s58, 2
    s_cbranch_scc1 L_F
    buffer_store_dwordx4 v[20:23], v1, s[8:11], s60 offen sc1
    s_branch L_F
L_A_fb:
    s_waitcnt vmcnt(0) lgkmcnt(0)
    v_mov_b32 v32, 0xff800000
    v_mov_b32 v33, 0xff800000
    v_mov_b32 v34, 0xff800000
    v_mov_b32 v35, 0xff800000
    s_mov_b32 s56, s90
    s_mov_b32 s59, 16
L_fb1:
    buffer_load_dwordx4 v[20:23], v1, s[8:11], s56 offen sc1
    s_add_u32 s56, s56, 2048
    s_waitcnt vmcnt(0)
    v_mfma_f32_32x32x16_bf16 v[44:59], v[20:23], v[4:7], 0
    s_nop 15
    v_max3_f32 v32, v32, v44, v45
    v_max3_f32 v32, v32, v46, v47
    v_max3_f32 v32, v32, v48, v49
    v_max3_f32 v32, v32, v50, v51
    v_max3_f32 v32, v32, v52, v53
    v_max3_f32 v32, v32, v54, v55
    v_max3_f32 v32, v32, v56, v57
    v_max3_f32 v32, v32, v58, v59
    v_mfma_f32_32x32x16_bf16 v[44:59], v[20:23], v[8:11], 0
    s_nop 15
    v_max3_f32 v33, v33, v44, v45
    v_max3_f32 v33, v33, v46, v47
    v_max3_f32 v33, v33, v48, v49
    v_max3_f32 v33, v33, v50, v51
    v_max3_f32 v33, v33, v52, v53
    v_max3_f32 v33, v33, v54, v55
    v_max3_f32 v33, v33, v56, v57
    v_max3_f32 v33, v33, v58, v59
    v_mfma_f32_32x32x16_bf16 v[44:59], v[20:23], v[12:15], 0
    s_nop 15
    v_max3_f32 v34, v34, v44, v45
    v_max3_f32 v34, v34, v46, v47
    v_max3_f32 v34, v34, v48, v49
    v_max3_f32 v34, v34, v50, v51
    v_max3_f32 v34, v34, v52, v53
    v_max3_f32 v34, v34, v54, v55
    v_max3_f32 v34, v34, v56, v57
    v_max3_f32 v34, v34, v58, v59
    v_mfma_f32_32x32x16_bf16 v[44:59], v[20:23], v[16:19], 0
    s_nop 15
    v_max3_f32 v35, v35, v44, v45
    v_max3_f32 v35, v35, v46, v47
    v_max3_f32 v35, v35, v48, v49
    v_max3_f32 v35, v35, v50, v51
    v_max3_f32 v35, v35, v52, v53
    v_max3_f32 v35, v35, v54, v55
    v_max3_f32 v35, v35, v56, v57
    v_max3_f32 v35, v35, v58, v59
    s_sub_u32 s59, s59, 1
    s_cmp_lg_u32 s59, 0
    s_cbranch_scc1 L_fb1
    v_lshrrev_b32 v148, 2, v1
    s_lshl_b32 s14, s92, 8
    v_add_u32 v149, s14, v148
    s_add_u32 s13, s92, 1
    s_and_b32 s13, s13, 3
    s_lshl_b32 s13, s13, 10
    s_add_u32 s13, s13, 132096
    v_add_u32 v150, s13, v149
    ds_write_b32 v150, v32
    s_add_u32 s13, s92, 2
    s_and_b32 s13, s13, 3
    s_lshl_b32 s13, s13, 10
    s_add_u32 s13, s13, 132096
    v_add_u32 v150, s13, v149
    ds_write_b32 v150, v33
    s_add_u32 s13, s92, 3
    s_and_b32 s13, s13, 3
    s_lshl_b32 s13, s13, 10
    s_add_u32 s13, s13, 132096
    v_add_u32 v150, s13, v149
    ds_write_b32 v150, v34
    s_add_u32 s13, s92, 4
    s_and_b32 s13, s13, 3
    s_lshl_b32 s13, s13, 10
    s_add_u32 s13, s13, 132096
    v_add_u32 v150, s13, v149
    ds_write_b32 v150, v35
    s_mov_b64 exec, 1
    ds_add_u32 v155, v154 offset:32
    s_mov_b64 exec, -1
    s_mov_b32 s61, 800000
L_f1:
    ds_read_b32 v152, v155 offset:32
    s_waitcnt lgkmcnt(0)
    v_readfirstlane_b32 s12, v152
    s_nop 1
    s_cmp_ge_u32 s12, 8
    s_cbranch_scc1 L_f1_ok
    s_sleep 1
    s_sub_u32 s61, s61, 1
    s_cmp_lg_u32 s61, 0
    s_cbranch_scc1 L_f1
L_f1_ok:
    v_and_b32 v149, 0x7c, v148
    s_add_u32 s13, s92, 1
    s_and_b32 s13, s13, 3
    s_lshl_b32 s13, s13, 10
    s_add_u32 s13, s13, 132096
    v_add_u32 v150, s13, v149
    ds_read_b32 v44, v150 offset:0
    ds_read_b32 v45, v150 offset:128
    ds_read_b32 v46, v150 offset:256
    ds_read_b32 v47, v150 offset:384
    ds_read_b32 v48, v150 offset:512
    ds_read_b32 v49, v150 offset:640
    ds_read_b32 v50, v150 offset:768
    ds_read_b32 v51, v150 offset:896
    s_waitcnt lgkmcnt(0)
    v_max3_f32 v32, v32, v44, v45
    v_max3_f32 v32, v32, v46, v47
    v_max3_f32 v32, v32, v48, v49
    v_max3_f32 v32, v32, v50, v51
    s_add_u32 s13, s92, 2
    s_and_b32 s13, s13, 3
    s_lshl_b32 s13, s13, 10
    s_add_u32 s13, s13, 132096
    v_add_u32 v150, s13, v149
    ds_read_b32 v44, v150 offset:0
    ds_read_b32 v45, v150 offset:128
    ds_read_b32 v46, v150 offset:256
    ds_read_b32 v47, v150 offset:384
    ds_read_b32 v48, v150 offset:512
    ds_read_b32 v49, v150 offset:640
    ds_read_b32 v50, v150 offset:768
    ds_read_b32 v51, v150 offset:896
    s_waitcnt lgkmcnt(0)
    v_max3_f32 v33, v33, v44, v45
    v_max3_f32 v33, v33, v46, v47
    v_max3_f32 v33, v33, v48, v49
    v_max3_f32 v33, v33, v50, v51
    s_add_u32 s13, s92, 3
    s_and_b32 s13, s13, 3
    s_lshl_b32 s13, s13, 10
    s_add_u32 s13, s13, 132096
    v_add_u32 v150, s13, v149
    ds_read_b32 v44, v150 offset:0
    ds_read_b32 v45, v150 offset:128
    ds_read_b32 v46, v150 offset:256
    ds_read_b32 v47, v150 offset:384
    ds_read_b32 v48, v150 offset:512
    ds_read_b32 v49, v150 offset:640
    ds_read_b32 v50, v150 offset:768
    ds_read_b32 v51, v150 offset:896
    s_waitcnt lgkmcnt(0)
    v_max3_f32 v34, v34, v44, v45
    v_max3_f32 v34, v34, v46, v47
    v_max3_f32 v34, v34, v48, v49
    v_max3_f32 v34, v34, v50, v51
    s_add_u32 s13, s92, 4
    s_and_b32 s13, s13, 3
    s_lshl_b32 s13, s13, 10
    s_add_u32 s13, s13, 132096
    v_add_u32 v150, s13, v149
    ds_read_b32 v44, v150 offset:0
    ds_read_b32 v45, v150 offset:128
    ds_read_b32 v46, v150 offset:256
    ds_read_b32 v47, v150 offset:384
    ds_read_b32 v48, v150 offset:512
    ds_read_b32 v49, v150 offset:640
    ds_read_b32 v50, v150 offset:768
    ds_read_b32 v51, v150 offset:896
    s_waitcnt lgkmcnt(0)
    v_max3_f32 v35, v35, v44, v45
    v_max3_f32 v35, v35, v46, v47
    v_max3_f32 v35, v35, v48, v49
    v_max3_f32 v35, v35, v50, v51
    s_mov_b64 exec, 1
    ds_add_u32 v155, v154 offset:32
    s_mov_b64 exec, -1
    v_mov_b32 v84, 0
    v_mov_b32 v85, 0
    v_mov_b32 v86, 0
    v_mov_b32 v87, 0
    v_mov_b32 v88, 0
    v_mov_b32 v89, 0
    v_mov_b32 v90, 0
    v_mov_b32 v91, 0
    v_mov_b32 v92, 0
    v_mov_b32 v93, 0
    v_mov_b32 v94, 0
    v_mov_b32 v95, 0
    v_mov_b32 v96, 0
    v_mov_b32 v97, 0
    v_mov_b32 v98, 0
    v_mov_b32 v99, 0
    v_mov_b32 v100, 0
    v_mov_b32 v101, 0
    v_mov_b32 v102, 0
    v_mov_b32 v103, 0
    v_mov_b32 v104, 0
    v_mov_b32 v105, 0
    v_mov_b32 v106, 0
    v_mov_b32 v107, 0
    v_mov_b32 v108, 0
    v_mov_b32 v109, 0
    v_mov_b32 v110, 0
    v_mov_b32 v111, 0
    v_mov_b32 v112, 0
    v_mov_b32 v113, 0
    v_mov_b32 v114, 0
    v_mov_b32 v115, 0
    v_mov_b32 v116, 0
    v_mov_b32 v117, 0
    v_mov_b32 v118, 0
    v_mov_b32 v119, 0
    v_mov_b32 v120, 0
    v_mov_b32 v121, 0
    v_mov_b32 v122, 0
    v_mov_b32 v123, 0
    v_mov_b32 v124, 0
    v_mov_b32 v125, 0
    v_mov_b32 v126, 0
    v_mov_b32 v127, 0
    v_mov_b32 v128, 0
    v_mov_b32 v129, 0
    v_mov_b32 v130, 0
    v_mov_b32 v131, 0
    v_mov_b32 v132, 0
    v_mov_b32 v133, 0
    v_mov_b32 v134, 0
    v_mov_b32 v135, 0
    v_mov_b32 v136, 0
    v_mov_b32 v137, 0
    v_mov_b32 v138, 0
    v_mov_b32 v139, 0
    v_mov_b32 v140, 0
    v_mov_b32 v141, 0
    v_mov_b32 v142, 0
    v_mov_b32 v143, 0
    v_mov_b32 v144, 0
    v_mov_b32 v145, 0
    v_mov_b32 v146, 0
    v_mov_b32 v147, 0
    s_mov_b32 s56, s90
    s_mov_b32 s59, 16
L_fb2:
    buffer_load_dwordx4 v[20:23], v1, s[8:11], s56 offen sc1
    s_mov_b64 exec, s[62:63]
    buffer_load_dwordx4 v[24:27], v2, s[8:11], s56 offen offset:1024 sc1
    buffer_load_dwordx4 v[28:31], v2, s[8:11], s56 offen offset:1536 sc1
    s_mov_b64 exec, -1
    s_add_u32 s56, s56, 2048
    s_waitcnt vmcnt(0)
    v_mfma_f32_32x32x16_bf16 v[44:59], v[20:23], v[4:7], 0
    s_nop 15
    v_sub_f32 v44, v44, v32
    v_sub_f32 v45, v45, v32
    v_sub_f32 v46, v46, v32
    v_sub_f32 v47, v47, v32
    v_sub_f32 v48, v48, v32
    v_sub_f32 v49, v49, v32
    v_sub_f32 v50, v50, v32
    v_sub_f32 v51, v51, v32
    v_sub_f32 v52, v52, v32
    v_sub_f32 v53, v53, v32
    v_sub_f32 v54, v54, v32
    v_sub_f32 v55, v55, v32
    v_sub_f32 v56, v56, v32
    v_sub_f32 v57, v57, v32
    v_sub_f32 v58, v58, v32
    v_sub_f32 v59, v59, v32
    v_exp_f32 v44, v44
    v_exp_f32 v45, v45
    v_exp_f32 v46, v46
    v_exp_f32 v47, v47
    v_exp_f32 v48, v48
    v_exp_f32 v49, v49
    v_exp_f32 v50, v50
    v_exp_f32 v51, v51
    v_exp_f32 v52, v52
    v_exp_f32 v53, v53
    v_exp_f32 v54, v54
    v_exp_f32 v55, v55
    v_exp_f32 v56, v56
    v_exp_f32 v57, v57
    v_exp_f32 v58, v58
    v_exp_f32 v59, v59
    s_nop 1
    v_smfmac_f32_32x32x32_bf16 v[84:99], v[24:27], v[44:51], v3
    v_smfmac_f32_32x32x32_bf16 v[84:99], v[28:31], v[52:59], v3
    v_mfma_f32_32x32x16_bf16 v[44:59], v[20:23], v[8:11], 0
    s_nop 15
    v_sub_f32 v44, v44, v33
    v_sub_f32 v45, v45, v33
    v_sub_f32 v46, v46, v33
    v_sub_f32 v47, v47, v33
    v_sub_f32 v48, v48, v33
    v_sub_f32 v49, v49, v33
    v_sub_f32 v50, v50, v33
    v_sub_f32 v51, v51, v33
    v_sub_f32 v52, v52, v33
    v_sub_f32 v53, v53, v33
    v_sub_f32 v54, v54, v33
    v_sub_f32 v55, v55, v33
    v_sub_f32 v56, v56, v33
    v_sub_f32 v57, v57, v33
    v_sub_f32 v58, v58, v33
    v_sub_f32 v59, v59, v33
    v_exp_f32 v44, v44
    v_exp_f32 v45, v45
    v_exp_f32 v46, v46
    v_exp_f32 v47, v47
    v_exp_f32 v48, v48
    v_exp_f32 v49, v49
    v_exp_f32 v50, v50
    v_exp_f32 v51, v51
    v_exp_f32 v52, v52
    v_exp_f32 v53, v53
    v_exp_f32 v54, v54
    v_exp_f32 v55, v55
    v_exp_f32 v56, v56
    v_exp_f32 v57, v57
    v_exp_f32 v58, v58
    v_exp_f32 v59, v59
    s_nop 1
    v_smfmac_f32_32x32x32_bf16 v[100:115], v[24:27], v[44:51], v3
    v_smfmac_f32_32x32x32_bf16 v[100:115], v[28:31], v[52:59], v3
    v_mfma_f32_32x32x16_bf16 v[44:59], v[20:23], v[12:15], 0
    s_nop 15
    v_sub_f32 v44, v44, v34
    v_sub_f32 v45, v45, v34
    v_sub_f32 v46, v46, v34
    v_sub_f32 v47, v47, v34
    v_sub_f32 v48, v48, v34
    v_sub_f32 v49, v49, v34
    v_sub_f32 v50, v50, v34
    v_sub_f32 v51, v51, v34
    v_sub_f32 v52, v52, v34
    v_sub_f32 v53, v53, v34
    v_sub_f32 v54, v54, v34
    v_sub_f32 v55, v55, v34
    v_sub_f32 v56, v56, v34
    v_sub_f32 v57, v57, v34
    v_sub_f32 v58, v58, v34
    v_sub_f32 v59, v59, v34
    v_exp_f32 v44, v44
    v_exp_f32 v45, v45
    v_exp_f32 v46, v46
    v_exp_f32 v47, v47
    v_exp_f32 v48, v48
    v_exp_f32 v49, v49
    v_exp_f32 v50, v50
    v_exp_f32 v51, v51
    v_exp_f32 v52, v52
    v_exp_f32 v53, v53
    v_exp_f32 v54, v54
    v_exp_f32 v55, v55
    v_exp_f32 v56, v56
    v_exp_f32 v57, v57
    v_exp_f32 v58, v58
    v_exp_f32 v59, v59
    s_nop 1
    v_smfmac_f32_32x32x32_bf16 v[116:131], v[24:27], v[44:51], v3
    v_smfmac_f32_32x32x32_bf16 v[116:131], v[28:31], v[52:59], v3
    v_mfma_f32_32x32x16_bf16 v[44:59], v[20:23], v[16:19], 0
    s_nop 15
    v_sub_f32 v44, v44, v35
    v_sub_f32 v45, v45, v35
    v_sub_f32 v46, v46, v35
    v_sub_f32 v47, v47, v35
    v_sub_f32 v48, v48, v35
    v_sub_f32 v49, v49, v35
    v_sub_f32 v50, v50, v35
    v_sub_f32 v51, v51, v35
    v_sub_f32 v52, v52, v35
    v_sub_f32 v53, v53, v35
    v_sub_f32 v54, v54, v35
    v_sub_f32 v55, v55, v35
    v_sub_f32 v56, v56, v35
    v_sub_f32 v57, v57, v35
    v_sub_f32 v58, v58, v35
    v_sub_f32 v59, v59, v35
    v_exp_f32 v44, v44
    v_exp_f32 v45, v45
    v_exp_f32 v46, v46
    v_exp_f32 v47, v47
    v_exp_f32 v48, v48
    v_exp_f32 v49, v49
    v_exp_f32 v50, v50
    v_exp_f32 v51, v51
    v_exp_f32 v52, v52
    v_exp_f32 v53, v53
    v_exp_f32 v54, v54
    v_exp_f32 v55, v55
    v_exp_f32 v56, v56
    v_exp_f32 v57, v57
    v_exp_f32 v58, v58
    v_exp_f32 v59, v59
    s_nop 1
    v_smfmac_f32_32x32x32_bf16 v[132:147], v[24:27], v[44:51], v3
    v_smfmac_f32_32x32x32_bf16 v[132:147], v[28:31], v[52:59], v3
    s_sub_u32 s59, s59, 1
    s_cmp_lg_u32 s59, 0
    s_cbranch_scc1 L_fb2
    s_nop 15
    s_mov_b32 s61, 800000
L_f2:
    ds_read_b32 v152, v155 offset:32
    s_waitcnt lgkmcnt(0)
    v_readfirstlane_b32 s12, v152
    s_nop 1
    s_cmp_ge_u32 s12, 12
    s_cbranch_scc1 L_f2_ok
    s_sleep 1
    s_sub_u32 s61, s61, 1
    s_cmp_lg_u32 s61, 0
    s_cbranch_scc1 L_f2
L_f2_ok:
    ds_write_b128 v156, v[84:87] offset:0
    ds_write_b128 v156, v[88:91] offset:1024
    ds_write_b32 v157, v92 offset:2048
    ds_write_b128 v158, v[100:103] offset:0
    ds_write_b128 v158, v[104:107] offset:1024
    ds_write_b32 v159, v108 offset:2048
    ds_write_b128 v160, v[116:119] offset:0
    ds_write_b128 v160, v[120:123] offset:1024
    ds_write_b32 v161, v124 offset:2048
    s_mov_b64 exec, 1
    ds_add_u32 v155, v154 offset:32
    s_mov_b64 exec, -1
    s_mov_b32 s59, 16
    s_branch L_A_fin
L_G:
    s_setprio 3
    s_barrier
    s_sub_u32 s7, s3, 8
    v_lshlrev_b32 v153, 4, v0
    v_lshrrev_b32 v1, 3, v0
    v_bfe_u32 v2, v0, 4, 1
    v_lshlrev_b32 v2, 2, v2
    v_and_b32 v3, 7, v0
    v_xor_b32 v2, v2, v3
    v_lshlrev_b32 v2, 4, v2
    s_lshl_b32 s58, s7, 14
    s_add_u32 s58, s58, 66560
    v_bfe_u32 v156, v0, 2, 2
    v_lshrrev_b32 v158, 5, v0
    v_lshl_add_u32 v156, v158, 2, v156
    v_and_b32 v158, 3, v0
    v_lshlrev_b32 v158, 3, v158
    v_bfe_u32 v159, v0, 4, 1
    v_lshl_add_u32 v158, v159, 5, v158
    v_lshl_add_u32 v160, v156, 6, v158
    v_add_u32 v160, s58, v160
    v_lshl_add_u32 v150, v156, 7, v158
    v_bfe_u32 v159, v0, 3, 1
    v_lshl_add_u32 v150, v159, 6, v150
    v_xor_b32 v151, 64, v150
    v_add_u32 v150, s58, v150
    v_add_u32 v151, s58, v151
    v_and_b32 v156, 31, v0
    v_mul_u32_u24 v152, 1040, v156
    v_lshrrev_b32 v158, 5, v0
    v_lshl_add_u32 v152, v158, 4, v152
    v_and_b32 v156, 31, v0
    v_lshrrev_b32 v158, 5, v0
    v_lshlrev_b32 v161, 1, v156
    v_lshl_add_u32 v161, v158, 20, v161
    s_waitcnt lgkmcnt(0)
    s_load_dword s6, s[40:41], 0
    s_mov_b32 s8, s40
    s_mov_b32 s9, s41
    s_mov_b32 s10, 16777216
    s_mov_b32 s11, 0x20000
    s_cmp_eq_u32 s7, 3
    s_cselect_b32 s44, s18, s28
    s_cselect_b32 s45, s19, s29
    s_mov_b32 s47, 0x20000
    s_cselect_b32 s13, 2, 7
    s_cselect_b32 s50, 0, 3584
    s_cselect_b32 s15, 0, s7
    s_mul_i32 s14, s13, s5
    s_add_u32 s14, s14, 1
    s_lshr_b32 s14, s14, 1
    s_lshl_b32 s13, s13, 9
    s_lshl_b32 s46, s13, 9
    s_add_u32 s14, s14, s15
    s_lshl_b32 s56, s14, 7
    v_and_b32 v156, 4, v1
    v_add_u32 v156, v156, v1
    v_mad_u32_u24 v148, v156, s13, v2
    s_lshl_b32 s57, s13, 4
    s_lshl_b32 s15, s13, 2
    s_sub_u32 s15, s15, 1024
    v_add_u32 v149, s15, v148
    s_mov_b32 s48, s30
    s_mov_b32 s49, s31
    s_mov_b32 s51, 0x20000
    s_cmp_ge_u32 s5, 4
    s_cselect_b32 s52, s22, s20
    s_cselect_b32 s53, s23, s21
    s_mov_b32 s54, 16384
    s_mov_b32 s55, 0x20000
    v_mov_b32 v164, 159744
    v_mov_b32 v165, 1
    v_mov_b32 v4, 0
    v_mov_b32 v5, 0
    ds_write_b64 v164, v[4:5] offset:0
    ds_write_b64 v164, v[4:5] offset:8
    ds_write_b64 v164, v[4:5] offset:16
    ds_write_b64 v164, v[4:5] offset:24
    ds_write_b64 v164, v[4:5] offset:32
    ds_write_b64 v164, v[4:5] offset:40
    ds_write_b64 v164, v[4:5] offset:48
    ds_write_b64 v164, v[4:5] offset:56
    ds_write_b64 v164, v[4:5] offset:64
    ds_write_b64 v164, v[4:5] offset:72
    ds_write_b64 v164, v[4:5] offset:80
    ds_write_b64 v164, v[4:5] offset:88
    ds_write_b64 v164, v[4:5] offset:96
    ds_write_b64 v164, v[4:5] offset:104
    ds_write_b64 v164, v[4:5] offset:112
    ds_write_b64 v164, v[4:5] offset:120
    ds_write_b64 v164, v[4:5] offset:128
    ds_write_b64 v164, v[4:5] offset:136
    s_setprio 0
    s_lshl_b32 s12, s7, 1
    s_add_u32 s12, s12, 0
    s_lshl_b32 s15, s12, 11
    s_add_u32 m0, s15, 140288
    s_add_u32 s12, s12, s42
    s_and_b32 s12, s12, 7
    s_lshl_b32 s12, s12, 11
    buffer_load_dwordx4 v153, s[52:55], s12 offen offset:0 lds
    buffer_load_dwordx4 v153, s[52:55], s12 offen offset:1024 lds
    s_lshl_b32 s12, s7, 1
    s_add_u32 s12, s12, 1
    s_lshl_b32 s15, s12, 11
    s_add_u32 m0, s15, 140288
    s_add_u32 s12, s12, s42
    s_and_b32 s12, s12, 7
    s_lshl_b32 s12, s12, 11
    buffer_load_dwordx4 v153, s[52:55], s12 offen offset:0 lds
    buffer_load_dwordx4 v153, s[52:55], s12 offen offset:1024 lds
    buffer_load_ushort v100, v161, s[48:51], s56 offen
    buffer_load_ushort v104, v161, s[48:51], s56 offen offset:64
    s_lshl_b32 s60, s14, 13
    s_mov_b32 s90, s56
    s_add_u32 s91, s90, s46
    s_lshl_b32 s12, s57, 2
    s_mul_i32 s12, s12, s42
    s_add_u32 s56, s56, s12
    s_add_u32 m0, s58, 0
    s_nop 0
    buffer_load_dwordx4 v148, s[44:47], s56 offen lds
    buffer_load_dwordx4 v149, s[44:47], s56 offen offset:1024 lds
    s_add_u32 s56, s56, s57
    s_add_u32 m0, s58, 2048
    s_nop 0
    buffer_load_dwordx4 v148, s[44:47], s56 offen lds
    buffer_load_dwordx4 v149, s[44:47], s56 offen offset:1024 lds
    s_add_u32 s56, s56, s57
    s_cmp_eq_u32 s56, s91
    s_cselect_b32 s56, s90, s56
    s_add_u32 m0, s58, 4096
    s_nop 0
    buffer_load_dwordx4 v148, s[44:47], s56 offen lds
    buffer_load_dwordx4 v149, s[44:47], s56 offen offset:1024 lds
    s_add_u32 s56, s56, s57
    s_add_u32 m0, s58, 6144
    s_nop 0
    buffer_load_dwordx4 v148, s[44:47], s56 offen lds
    buffer_load_dwordx4 v149, s[44:47], s56 offen offset:1024 lds
    s_add_u32 s56, s56, s57
    s_cmp_eq_u32 s56, s91
    s_cselect_b32 s56, s90, s56
    s_add_u32 m0, s58, 8192
    s_nop 0
    buffer_load_dwordx4 v148, s[44:47], s56 offen lds
    buffer_load_dwordx4 v149, s[44:47], s56 offen offset:1024 lds
    s_add_u32 s56, s56, s57
    s_add_u32 m0, s58, 10240
    s_nop 0
    buffer_load_dwordx4 v148, s[44:47], s56 offen lds
    buffer_load_dwordx4 v149, s[44:47], s56 offen offset:1024 lds
    s_add_u32 s56, s56, s57
    s_cmp_eq_u32 s56, s91
    s_cselect_b32 s56, s90, s56
    v_mov_b32 v101, 0
    v_mov_b32 v102, 0
    v_mov_b32 v103, 0
    v_mov_b32 v105, 0
    v_mov_b32 v106, 0
    v_mov_b32 v107, 0
    v_mov_b32 v109, 0
    v_mov_b32 v110, 0
    v_mov_b32 v111, 0
    v_mov_b32 v108, 0x3f80
    v_lshl_add_u32 v154, v1, 10, v2
    v_add_u32 v155, 7168, v154
    s_waitcnt vmcnt(14) lgkmcnt(0)
    s_add_u32 s6, s6, 0x9e3779b1
    s_barrier
    s_add_u32 m0, s58, 12288
    s_nop 0
    buffer_load_dwordx4 v148, s[44:47], s56 offen lds
    buffer_load_dwordx4 v149, s[44:47], s56 offen offset:1024 lds
    s_add_u32 s56, s56, s57
    s_add_u32 m0, s58, 14336
    s_nop 0
    buffer_load_dwordx4 v148, s[44:47], s56 offen lds
    buffer_load_dwordx4 v149, s[44:47], s56 offen offset:1024 lds
    s_add_u32 s56, s56, s57
    s_cmp_eq_u32 s56, s91
    s_cselect_b32 s56, s90, s56
    ds_read_b128 v[68:71], v152 offset:0
    ds_read_b128 v[72:75], v152 offset:33280
    s_waitcnt vmcnt(14)
    ds_read_b64_tr_b16 v[132:133], v150 offset:0
    ds_read_b64_tr_b16 v[134:135], v150 offset:1024
    ds_read_b64_tr_b16 v[136:137], v151 offset:0
    ds_read_b64_tr_b16 v[138:139], v151 offset:1024
    v_mfma_f32_32x32x16_bf16 v[4:19], v[100:103], v[108:111], 0
    v_mfma_f32_32x32x16_bf16 v[20:35], v[104:107], v[108:111], 0
    v_mfma_f32_32x32x16_bf16 v[36:51], v[100:103], v[108:111], 0
    v_mfma_f32_32x32x16_bf16 v[52:67], v[104:107], v[108:111], 0
    s_mov_b32 s59, 3
L_g1:
    s_waitcnt lgkmcnt(0)
    v_mfma_f32_32x32x16_bf16 v[4:19], v[132:135], v[68:71], v[4:19]
    s_waitcnt vmcnt(12)
    ds_read_b64_tr_b16 v[140:141], v150 offset:2048
    ds_read_b64_tr_b16 v[142:143], v150 offset:3072
    ds_read_b64_tr_b16 v[144:145], v151 offset:2048
    ds_read_b64_tr_b16 v[146:147], v151 offset:3072
    v_mfma_f32_32x32x16_bf16 v[36:51], v[132:135], v[72:75], v[36:51]
    ds_read_b128 v[76:79], v152 offset:32
    ds_read_b128 v[80:83], v152 offset:33312
    v_mfma_f32_32x32x16_bf16 v[20:35], v[136:139], v[68:71], v[20:35]
    s_add_u32 m0, s58, 0
    s_nop 0
    buffer_load_dwordx4 v148, s[44:47], s56 offen lds
    v_mfma_f32_32x32x16_bf16 v[52:67], v[136:139], v[72:75], v[52:67]
    buffer_load_dwordx4 v149, s[44:47], s56 offen offset:1024 lds
    s_add_u32 s56, s56, s57
    s_waitcnt lgkmcnt(0)
    v_mfma_f32_32x32x16_bf16 v[4:19], v[140:143], v[76:79], v[4:19]
    s_waitcnt vmcnt(12)
    ds_read_b64_tr_b16 v[132:133], v150 offset:4096
    ds_read_b64_tr_b16 v[134:135], v150 offset:5120
    ds_read_b64_tr_b16 v[136:137], v151 offset:4096
    ds_read_b64_tr_b16 v[138:139], v151 offset:5120
    v_mfma_f32_32x32x16_bf16 v[36:51], v[140:143], v[80:83], v[36:51]
    ds_read_b128 v[68:71], v152 offset:64
    ds_read_b128 v[72:75], v152 offset:33344
    v_mfma_f32_32x32x16_bf16 v[20:35], v[144:147], v[76:79], v[20:35]
    s_add_u32 m0, s58, 2048
    s_nop 0
    buffer_load_dwordx4 v148, s[44:47], s56 offen lds
    v_mfma_f32_32x32x16_bf16 v[52:67], v[144:147], v[80:83], v[52:67]
    buffer_load_dwordx4 v149, s[44:47], s56 offen offset:1024 lds
    s_add_u32 s56, s56, s57
    s_cmp_eq_u32 s56, s91
    s_cselect_b32 s56, s90, s56
    s_waitcnt lgkmcnt(0)
    v_mfma_f32_32x32x16_bf16 v[4:19], v[132:135], v[68:71], v[4:19]
    s_waitcnt vmcnt(12)
    ds_read_b64_tr_b16 v[140:141], v150 offset:6144
    ds_read_b64_tr_b16 v[142:143], v150 offset:7168
    ds_read_b64_tr_b16 v[144:145], v151 offset:6144
    ds_read_b64_tr_b16 v[146:147], v151 offset:7168
    v_mfma_f32_32x32x16_bf16 v[36:51], v[132:135], v[72:75], v[36:51]
    ds_read_b128 v[76:79], v152 offset:96
    ds_read_b128 v[80:83], v152 offset:33376
    v_mfma_f32_32x32x16_bf16 v[20:35], v[136:139], v[68:71], v[20:35]
    s_add_u32 m0, s58, 4096
    s_nop 0
    buffer_load_dwordx4 v148, s[44:47], s56 offen lds
    v_mfma_f32_32x32x16_bf16 v[52:67], v[136:139], v[72:75], v[52:67]
    buffer_load_dwordx4 v149, s[44:47], s56 offen offset:1024 lds
    s_add_u32 s56, s56, s57
    s_waitcnt lgkmcnt(0)
    v_mfma_f32_32x32x16_bf16 v[4:19], v[140:143], v[76:79], v[4:19]
    s_waitcnt vmcnt(12)
    ds_read_b64_tr_b16 v[132:133], v150 offset:8192
    ds_read_b64_tr_b16 v[134:135], v150 offset:9216
    ds_read_b64_tr_b16 v[136:137], v151 offset:8192
    ds_read_b64_tr_b16 v[138:139], v151 offset:9216
    v_mfma_f32_32x32x16_bf16 v[36:51], v[140:143], v[80:83], v[36:51]
    ds_read_b128 v[68:71], v152 offset:128
    ds_read_b128 v[72:75], v152 offset:33408
    v_mfma_f32_32x32x16_bf16 v[20:35], v[144:147], v[76:79], v[20:35]
    s_add_u32 m0, s58, 6144
    s_nop 0
    buffer_load_dwordx4 v148, s[44:47], s56 offen lds
    v_mfma_f32_32x32x16_bf16 v[52:67], v[144:147], v[80:83], v[52:67]
    buffer_load_dwordx4 v149, s[44:47], s56 offen offset:1024 lds
    s_add_u32 s56, s56, s57
    s_cmp_eq_u32 s56, s91
    s_cselect_b32 s56, s90, s56
    s_waitcnt lgkmcnt(0)
    v_mfma_f32_32x32x16_bf16 v[4:19], v[132:135], v[68:71], v[4:19]
    s_waitcnt vmcnt(12)
    ds_read_b64_tr_b16 v[140:141], v150 offset:10240
    ds_read_b64_tr_b16 v[142:143], v150 offset:11264
    ds_read_b64_tr_b16 v[144:145], v151 offset:10240
    ds_read_b64_tr_b16 v[146:147], v151 offset:11264
    v_mfma_f32_32x32x16_bf16 v[36:51], v[132:135], v[72:75], v[36:51]
    ds_read_b128 v[76:79], v152 offset:160
    ds_read_b128 v[80:83], v152 offset:33440
    v_mfma_f32_32x32x16_bf16 v[20:35], v[136:139], v[68:71], v[20:35]
    s_add_u32 m0, s58, 8192
    s_nop 0
    buffer_load_dwordx4 v148, s[44:47], s56 offen lds
    v_mfma_f32_32x32x16_bf16 v[52:67], v[136:139], v[72:75], v[52:67]
    buffer_load_dwordx4 v149, s[44:47], s56 offen offset:1024 lds
    s_add_u32 s56, s56, s57
    s_waitcnt lgkmcnt(0)
    v_mfma_f32_32x32x16_bf16 v[4:19], v[140:143], v[76:79], v[4:19]
    s_waitcnt vmcnt(12)
    ds_read_b64_tr_b16 v[132:133], v150 offset:12288
    ds_read_b64_tr_b16 v[134:135], v150 offset:13312
    ds_read_b64_tr_b16 v[136:137], v151 offset:12288
    ds_read_b64_tr_b16 v[138:139], v151 offset:13312
    v_mfma_f32_32x32x16_bf16 v[36:51], v[140:143], v[80:83], v[36:51]
    ds_read_b128 v[68:71], v152 offset:192
    ds_read_b128 v[72:75], v152 offset:33472
    v_mfma_f32_32x32x16_bf16 v[20:35], v[144:147], v[76:79], v[20:35]
    s_add_u32 m0, s58, 10240
    s_nop 0
    buffer_load_dwordx4 v148, s[44:47], s56 offen lds
    v_mfma_f32_32x32x16_bf16 v[52:67], v[144:147], v[80:83], v[52:67]
    buffer_load_dwordx4 v149, s[44:47], s56 offen offset:1024 lds
    s_add_u32 s56, s56, s57
    s_cmp_eq_u32 s56, s91
    s_cselect_b32 s56, s90, s56
    s_waitcnt lgkmcnt(0)
    v_mfma_f32_32x32x16_bf16 v[4:19], v[132:135], v[68:71], v[4:19]
    s_waitcnt vmcnt(12)
    ds_read_b64_tr_b16 v[140:141], v150 offset:14336
    ds_read_b64_tr_b16 v[142:143], v150 offset:15360
    ds_read_b64_tr_b16 v[144:145], v151 offset:14336
    ds_read_b64_tr_b16 v[146:147], v151 offset:15360
    v_mfma_f32_32x32x16_bf16 v[36:51], v[132:135], v[72:75], v[36:51]
    ds_read_b128 v[76:79], v152 offset:224
    ds_read_b128 v[80:83], v152 offset:33504
    v_mfma_f32_32x32x16_bf16 v[20:35], v[136:139], v[68:71], v[20:35]
    s_add_u32 m0, s58, 12288
    s_nop 0
    buffer_load_dwordx4 v148, s[44:47], s56 offen lds
    v_mfma_f32_32x32x16_bf16 v[52:67], v[136:139], v[72:75], v[52:67]
    buffer_load_dwordx4 v149, s[44:47], s56 offen offset:1024 lds
    s_add_u32 s56, s56, s57
    s_waitcnt lgkmcnt(0)
    v_mfma_f32_32x32x16_bf16 v[4:19], v[140:143], v[76:79], v[4:19]
    s_waitcnt vmcnt(12)
    ds_read_b64_tr_b16 v[132:133], v150 offset:0
    ds_read_b64_tr_b16 v[134:135], v150 offset:1024
    ds_read_b64_tr_b16 v[136:137], v151 offset:0
    ds_read_b64_tr_b16 v[138:139], v151 offset:1024
    v_mfma_f32_32x32x16_bf16 v[36:51], v[140:143], v[80:83], v[36:51]
    ds_read_b128 v[68:71], v152 offset:256
    ds_read_b128 v[72:75], v152 offset:33536
    v_mfma_f32_32x32x16_bf16 v[20:35], v[144:147], v[76:79], v[20:35]
    s_add_u32 m0, s58, 14336
    s_nop 0
    buffer_load_dwordx4 v148, s[44:47], s56 offen lds
    v_mfma_f32_32x32x16_bf16 v[52:67], v[144:147], v[80:83], v[52:67]
    buffer_load_dwordx4 v149, s[44:47], s56 offen offset:1024 lds
    s_add_u32 s56, s56, s57
    s_cmp_eq_u32 s56, s91
    s_cselect_b32 s56, s90, s56
    v_add_u32 v152, 256, v152
    s_sub_u32 s59, s59, 1
    s_cmp_lg_u32 s59, 0
    s_cbranch_scc1 L_g1
    s_setprio 3
    s_barrier
    s_waitcnt lgkmcnt(0)
    v_mfma_f32_32x32x16_bf16 v[4:19], v[132:135], v[68:71], v[4:19]
    s_waitcnt vmcnt(12)
    ds_read_b64_tr_b16 v[140:141], v150 offset:2048
    ds_read_b64_tr_b16 v[142:143], v150 offset:3072
    ds_read_b64_tr_b16 v[144:145], v151 offset:2048
    ds_read_b64_tr_b16 v[146:147], v151 offset:3072
    v_mfma_f32_32x32x16_bf16 v[36:51], v[132:135], v[72:75], v[36:51]
    ds_read_b128 v[76:79], v152 offset:32
    ds_read_b128 v[80:83], v152 offset:33312
    v_bfe_u32 v156, v0, 2, 2
    v_bfe_u32 v157, v0, 4, 1
    v_lshl_add_u32 v156, v157, 3, v156
    v_mfma_f32_32x32x16_bf16 v[20:35], v[136:139], v[68:71], v[20:35]
    v_lshrrev_b32 v157, 5, v0
    v_lshl_add_u32 v156, v157, 2, v156
    v_and_b32 v157, 3, v0
    v_mul_u32_u24 v156, 3584, v156
    v_lshl_add_u32 v112, v157, 4, v156
    v_mfma_f32_32x32x16_bf16 v[52:67], v[136:139], v[72:75], v[52:67]
    v_add_u32 v113, 56320, v112
    s_mul_i32 s15, s4, 229376
    s_add_u32 s15, s15, 4194304
    s_add_u32 s60, s60, s15
    s_mov_b32 s44, s28
    s_waitcnt lgkmcnt(0)
    v_mfma_f32_32x32x16_bf16 v[4:19], v[140:143], v[76:79], v[4:19]
    s_waitcnt vmcnt(10)
    ds_read_b64_tr_b16 v[132:133], v150 offset:4096
    ds_read_b64_tr_b16 v[134:135], v150 offset:5120
    ds_read_b64_tr_b16 v[136:137], v151 offset:4096
    ds_read_b64_tr_b16 v[138:139], v151 offset:5120
    v_mfma_f32_32x32x16_bf16 v[36:51], v[140:143], v[80:83], v[36:51]
    ds_read_b128 v[68:71], v152 offset:64
    ds_read_b128 v[72:75], v152 offset:33344
    s_mov_b32 s45, s29
    s_mov_b32 s46, 1835008
    s_mul_i32 s90, s5, 448
    v_mfma_f32_32x32x16_bf16 v[20:35], v[144:147], v[76:79], v[20:35]
    s_bitcmp1_b32 s5, 0
    s_cselect_b32 s12, 0, 384
    s_add_u32 s90, s90, s12
    s_mov_b32 s57, 114688
    s_add_u32 s91, s90, 1835008
    v_mfma_f32_32x32x16_bf16 v[52:67], v[144:147], v[80:83], v[52:67]
    s_lshl_b32 s12, s7, 1
    s_add_u32 s12, s12, s42
    s_and_b32 s12, s12, 7
    s_mul_i32 s12, s12, 229376
    s_add_u32 s56, s90, s12
    s_waitcnt lgkmcnt(0)
    v_mfma_f32_32x32x16_bf16 v[4:19], v[132:135], v[68:71], v[4:19]
    s_waitcnt vmcnt(8)
    ds_read_b64_tr_b16 v[140:141], v150 offset:6144
    ds_read_b64_tr_b16 v[142:143], v150 offset:7168
    ds_read_b64_tr_b16 v[144:145], v151 offset:6144
    ds_read_b64_tr_b16 v[146:147], v151 offset:7168
    v_mfma_f32_32x32x16_bf16 v[36:51], v[132:135], v[72:75], v[36:51]
    ds_read_b128 v[76:79], v152 offset:96
    ds_read_b128 v[80:83], v152 offset:33376
    s_lshl_b32 s12, s4, 3
    s_add_u32 s12, s12, s5
    s_lshl_b32 s14, s12, 13
    v_mfma_f32_32x32x16_bf16 v[20:35], v[136:139], v[68:71], v[20:35]
    s_add_u32 s14, s14, 1048576
    s_lshl_b32 s12, s12, 2
    s_add_u32 s12, s12, s7
    s_lshl_b32 s12, s12, 7
    s_add_u32 s93, s12, 65536
    v_mfma_f32_32x32x16_bf16 v[52:67], v[136:139], v[72:75], v[52:67]
    s_cmp_eq_u32 s7, 3
    s_cselect_b32 s50, 3584, 0
    s_cselect_b32 s60, s14, s60
    s_cselect_b64 vcc, -1, 0
    s_add_u32 s13, s60, 4096
    s_waitcnt lgkmcnt(0)
    v_mfma_f32_32x32x16_bf16 v[4:19], v[140:143], v[76:79], v[4:19]
    s_waitcnt vmcnt(6)
    ds_read_b64_tr_b16 v[132:133], v150 offset:8192
    ds_read_b64_tr_b16 v[134:135], v150 offset:9216
    ds_read_b64_tr_b16 v[136:137], v151 offset:8192
    ds_read_b64_tr_b16 v[138:139], v151 offset:9216
    v_mfma_f32_32x32x16_bf16 v[36:51], v[140:143], v[80:83], v[36:51]
    ds_read_b128 v[68:71], v152 offset:128
    ds_read_b128 v[72:75], v152 offset:33408
    s_sub_u32 s12, 3, s7
    s_lshl_b32 s12, s12, 8
    v_subrev_u32 v162, s12, v152
    v_mfma_f32_32x32x16_bf16 v[20:35], v[144:147], v[76:79], v[20:35]
    v_add_u32 v114, s58, v153
    s_lshl_b32 s12, s7, 11
    s_add_u32 s12, s12, 66560
    v_add_u32 v115, s12, v153
    v_bfe_u32 v156, v0, 4, 2
    v_mfma_f32_32x32x16_bf16 v[52:67], v[144:147], v[80:83], v[52:67]
    v_lshlrev_b32 v156, 1, v156
    v_xor_b32 v156, v156, v3
    v_lshlrev_b32 v156, 4, v156
    v_lshl_add_u32 v116, v1, 10, v156
    v_add_u32 v117, 7168, v116
    s_waitcnt lgkmcnt(0)
    v_mfma_f32_32x32x16_bf16 v[4:19], v[132:135], v[68:71], v[4:19]
    s_waitcnt vmcnt(4)
    ds_read_b64_tr_b16 v[140:141], v150 offset:10240
    ds_read_b64_tr_b16 v[142:143], v150 offset:11264
    ds_read_b64_tr_b16 v[144:145], v151 offset:10240
    ds_read_b64_tr_b16 v[146:147], v151 offset:11264
    v_mfma_f32_32x32x16_bf16 v[36:51], v[132:135], v[72:75], v[36:51]
    ds_read_b128 v[76:79], v152 offset:160
    ds_read_b128 v[80:83], v152 offset:33440
    v_lshlrev_b32 v118, 7, v3
    v_mov_b32 v163, s6
    v_and_b32 v156, 15, v0
    v_mfma_f32_32x32x16_bf16 v[20:35], v[136:139], v[68:71], v[20:35]
    v_lshrrev_b32 v157, 4, v0
    v_lshlrev_b32 v119, 10, v156
    v_lshl_add_u32 v119, v157, 3, v119
    v_xor_b32 v128, v156, v157
    v_lshlrev_b32 v128, 4, v128
    v_mfma_f32_32x32x16_bf16 v[52:67], v[136:139], v[72:75], v[52:67]
    v_lshl_add_u32 v128, v156, 8, v128
    s_lshl_b32 s12, s7, 12
    s_add_u32 s12, s12, 66560
    v_add_u32 v128, s12, v128
    v_add_u32 v167, s12, v153
    s_waitcnt lgkmcnt(0)
    v_mfma_f32_32x32x16_bf16 v[4:19], v[140:143], v[76:79], v[4:19]
    s_waitcnt vmcnt(2)
    ds_read_b64_tr_b16 v[132:133], v150 offset:12288
    ds_read_b64_tr_b16 v[134:135], v150 offset:13312
    ds_read_b64_tr_b16 v[136:137], v151 offset:12288
    ds_read_b64_tr_b16 v[138:139], v151 offset:13312
    v_mfma_f32_32x32x16_bf16 v[36:51], v[140:143], v[80:83], v[36:51]
    ds_read_b128 v[68:71], v152 offset:192
    ds_read_b128 v[72:75], v152 offset:33472
    v_xor_b32 v129, 64, v128
    v_xor_b32 v130, 128, v128
    v_xor_b32 v131, 192, v128
    v_mfma_f32_32x32x16_bf16 v[20:35], v[144:147], v[76:79], v[20:35]
    v_lshrrev_b32 v120, 5, v0
    v_xor_b32 v120, v120, v156
    v_lshlrev_b32 v120, 4, v120
    v_and_b32 v157, 31, v0
    v_lshl_add_u32 v120, v157, 8, v120
    v_mfma_f32_32x32x16_bf16 v[52:67], v[144:147], v[80:83], v[52:67]
    v_add_u32 v120, s58, v120
    v_xor_b32 v121, 32, v120
    v_xor_b32 v122, 64, v120
    v_xor_b32 v123, 96, v120
    v_xor_b32 v124, 128, v120
    s_waitcnt lgkmcnt(0)
    v_mfma_f32_32x32x16_bf16 v[4:19], v[132:135], v[68:71], v[4:19]
    s_waitcnt vmcnt(0)
    ds_read_b64_tr_b16 v[140:141], v150 offset:14336
    ds_read_b64_tr_b16 v[142:143], v150 offset:15360
    ds_read_b64_tr_b16 v[144:145], v151 offset:14336
    ds_read_b64_tr_b16 v[146:147], v151 offset:15360
    v_mfma_f32_32x32x16_bf16 v[36:51], v[132:135], v[72:75], v[36:51]
    ds_read_b128 v[76:79], v152 offset:224
    ds_read_b128 v[80:83], v152 offset:33504
    v_xor_b32 v125, 160, v120
    v_xor_b32 v126, 192, v120
    v_xor_b32 v127, 224, v120
    v_mfma_f32_32x32x16_bf16 v[20:35], v[136:139], v[68:71], v[20:35]
    s_lshl_b32 s12, s7, 3
    v_add_u32 v166, s12, v164
    v_add_u32 v148, 132096, v153
    v_mov_b32 v149, 2
    v_mov_b32 v156, -1
    v_mfma_f32_32x32x16_bf16 v[52:67], v[136:139], v[72:75], v[52:67]
    v_mov_b32 v157, -1
    v_mov_b32 v158, -1
    v_mov_b32 v159, -1
    s_setprio 3
    ds_write_b32 v164, v165 offset:80
    s_waitcnt lgkmcnt(0)
    v_mfma_f32_32x32x16_bf16 v[4:19], v[140:143], v[76:79], v[4:19]
    v_mfma_f32_32x32x16_bf16 v[36:51], v[140:143], v[80:83], v[36:51]
    v_mfma_f32_32x32x16_bf16 v[20:35], v[144:147], v[76:79], v[20:35]
    v_mfma_f32_32x32x16_bf16 v[52:67], v[144:147], v[80:83], v[52:67]
    s_nop 7
    s_cbranch_vccz L_g_h
    v_cvt_pk_bf16_f32 v68, v4, v5
    v_cvt_pk_bf16_f32 v69, v6, v7
    v_cvt_pk_bf16_f32 v70, v8, v9
    v_cvt_pk_bf16_f32 v71, v10, v11
    ds_write_b128 v148, v[68:71] offset:0
    v_cvt_pk_bf16_f32 v76, v12, v13
    v_cvt_pk_bf16_f32 v77, v14, v15
    v_cvt_pk_bf16_f32 v78, v16, v17
    v_cvt_pk_bf16_f32 v79, v18, v19
    ds_write_b128 v148, v[76:79] offset:2048
    v_cvt_pk_bf16_f32 v72, v36, v37
    v_cvt_pk_bf16_f32 v73, v38, v39
    v_cvt_pk_bf16_f32 v74, v40, v41
    v_cvt_pk_bf16_f32 v75, v42, v43
    ds_write_b128 v148, v[72:75] offset:1024
    v_cvt_pk_bf16_f32 v80, v44, v45
    v_cvt_pk_bf16_f32 v81, v46, v47
    v_cvt_pk_bf16_f32 v82, v48, v49
    v_cvt_pk_bf16_f32 v83, v50, v51
    ds_write_b128 v148, v[80:83] offset:3072
    ds_write_b32 v164, v165 offset:0
    v_cvt_pk_bf16_f32 v84, v20, v21
    v_cvt_pk_bf16_f32 v85, v22, v23
    v_cvt_pk_bf16_f32 v86, v24, v25
    v_cvt_pk_bf16_f32 v87, v26, v27
    ds_write_b128 v148, v[84:87] offset:4096
    v_cvt_pk_bf16_f32 v92, v28, v29
    v_cvt_pk_bf16_f32 v93, v30, v31
    v_cvt_pk_bf16_f32 v94, v32, v33
    v_cvt_pk_bf16_f32 v95, v34, v35
    ds_write_b128 v148, v[92:95] offset:6144
    v_cvt_pk_bf16_f32 v88, v52, v53
    v_cvt_pk_bf16_f32 v89, v54, v55
    v_cvt_pk_bf16_f32 v90, v56, v57
    v_cvt_pk_bf16_f32 v91, v58, v59
    ds_write_b128 v148, v[88:91] offset:5120
    v_cvt_pk_bf16_f32 v96, v60, v61
    v_cvt_pk_bf16_f32 v97, v62, v63
    v_cvt_pk_bf16_f32 v98, v64, v65
    v_cvt_pk_bf16_f32 v99, v66, v67
    ds_write_b128 v148, v[96:99] offset:7168
    ds_write_b32 v164, v149 offset:0
    s_branch L_g_x
L_g_h:
    v_max_f32 v4, 0, v4
    v_max_f32 v5, 0, v5
    v_pk_mul_f32 v[4:5], v[4:5], v[4:5]
    v_cvt_pk_bf16_f32 v68, v4, v5
    v_max_f32 v6, 0, v6
    v_max_f32 v7, 0, v7
    v_pk_mul_f32 v[6:7], v[6:7], v[6:7]
    v_cvt_pk_bf16_f32 v69, v6, v7
    v_max_f32 v8, 0, v8
    v_max_f32 v9, 0, v9
    v_pk_mul_f32 v[8:9], v[8:9], v[8:9]
    v_cvt_pk_bf16_f32 v70, v8, v9
    v_max_f32 v10, 0, v10
    v_max_f32 v11, 0, v11
    v_pk_mul_f32 v[10:11], v[10:11], v[10:11]
    v_cvt_pk_bf16_f32 v71, v10, v11
    v_max_f32 v12, 0, v12
    v_max_f32 v13, 0, v13
    v_pk_mul_f32 v[12:13], v[12:13], v[12:13]
    v_cvt_pk_bf16_f32 v76, v12, v13
    v_max_f32 v14, 0, v14
    v_max_f32 v15, 0, v15
    v_pk_mul_f32 v[14:15], v[14:15], v[14:15]
    v_cvt_pk_bf16_f32 v77, v14, v15
    v_max_f32 v16, 0, v16
    v_max_f32 v17, 0, v17
    v_pk_mul_f32 v[16:17], v[16:17], v[16:17]
    v_cvt_pk_bf16_f32 v78, v16, v17
    v_max_f32 v18, 0, v18
    v_max_f32 v19, 0, v19
    v_pk_mul_f32 v[18:19], v[18:19], v[18:19]
    v_cvt_pk_bf16_f32 v79, v18, v19
    v_max_f32 v36, 0, v36
    v_max_f32 v37, 0, v37
    v_pk_mul_f32 v[36:37], v[36:37], v[36:37]
    v_cvt_pk_bf16_f32 v72, v36, v37
    v_max_f32 v38, 0, v38
    v_max_f32 v39, 0, v39
    v_pk_mul_f32 v[38:39], v[38:39], v[38:39]
    v_cvt_pk_bf16_f32 v73, v38, v39
    v_max_f32 v40, 0, v40
    v_max_f32 v41, 0, v41
    v_pk_mul_f32 v[40:41], v[40:41], v[40:41]
    v_cvt_pk_bf16_f32 v74, v40, v41
    v_max_f32 v42, 0, v42
    v_max_f32 v43, 0, v43
    v_pk_mul_f32 v[42:43], v[42:43], v[42:43]
    v_cvt_pk_bf16_f32 v75, v42, v43
    v_max_f32 v44, 0, v44
    v_max_f32 v45, 0, v45
    v_pk_mul_f32 v[44:45], v[44:45], v[44:45]
    v_cvt_pk_bf16_f32 v80, v44, v45
    v_max_f32 v46, 0, v46
    v_max_f32 v47, 0, v47
    v_pk_mul_f32 v[46:47], v[46:47], v[46:47]
    v_cvt_pk_bf16_f32 v81, v46, v47
    v_max_f32 v48, 0, v48
    v_max_f32 v49, 0, v49
    v_pk_mul_f32 v[48:49], v[48:49], v[48:49]
    v_cvt_pk_bf16_f32 v82, v48, v49
    v_max_f32 v50, 0, v50
    v_max_f32 v51, 0, v51
    v_pk_mul_f32 v[50:51], v[50:51], v[50:51]
    v_cvt_pk_bf16_f32 v83, v50, v51
    v_max_f32 v20, 0, v20
    v_max_f32 v21, 0, v21
    v_pk_mul_f32 v[20:21], v[20:21], v[20:21]
    v_cvt_pk_bf16_f32 v84, v20, v21
    v_max_f32 v22, 0, v22
    v_max_f32 v23, 0, v23
    v_pk_mul_f32 v[22:23], v[22:23], v[22:23]
    v_cvt_pk_bf16_f32 v85, v22, v23
    v_max_f32 v24, 0, v24
    v_max_f32 v25, 0, v25
    v_pk_mul_f32 v[24:25], v[24:25], v[24:25]
    v_cvt_pk_bf16_f32 v86, v24, v25
    v_max_f32 v26, 0, v26
    v_max_f32 v27, 0, v27
    v_pk_mul_f32 v[26:27], v[26:27], v[26:27]
    v_cvt_pk_bf16_f32 v87, v26, v27
    v_max_f32 v28, 0, v28
    v_max_f32 v29, 0, v29
    v_pk_mul_f32 v[28:29], v[28:29], v[28:29]
    v_cvt_pk_bf16_f32 v92, v28, v29
    v_max_f32 v30, 0, v30
    v_max_f32 v31, 0, v31
    v_pk_mul_f32 v[30:31], v[30:31], v[30:31]
    v_cvt_pk_bf16_f32 v93, v30, v31
    v_max_f32 v32, 0, v32
    v_max_f32 v33, 0, v33
    v_pk_mul_f32 v[32:33], v[32:33], v[32:33]
    v_cvt_pk_bf16_f32 v94, v32, v33
    v_max_f32 v34, 0, v34
    v_max_f32 v35, 0, v35
    v_pk_mul_f32 v[34:35], v[34:35], v[34:35]
    v_cvt_pk_bf16_f32 v95, v34, v35
    v_max_f32 v52, 0, v52
    v_max_f32 v53, 0, v53
    v_pk_mul_f32 v[52:53], v[52:53], v[52:53]
    v_cvt_pk_bf16_f32 v88, v52, v53
    v_max_f32 v54, 0, v54
    v_max_f32 v55, 0, v55
    v_pk_mul_f32 v[54:55], v[54:55], v[54:55]
    v_cvt_pk_bf16_f32 v89, v54, v55
    v_max_f32 v56, 0, v56
    v_max_f32 v57, 0, v57
    v_pk_mul_f32 v[56:57], v[56:57], v[56:57]
    v_cvt_pk_bf16_f32 v90, v56, v57
    v_max_f32 v58, 0, v58
    v_max_f32 v59, 0, v59
    v_pk_mul_f32 v[58:59], v[58:59], v[58:59]
    v_cvt_pk_bf16_f32 v91, v58, v59
    v_max_f32 v60, 0, v60
    v_max_f32 v61, 0, v61
    v_pk_mul_f32 v[60:61], v[60:61], v[60:61]
    v_cvt_pk_bf16_f32 v96, v60, v61
    v_max_f32 v62, 0, v62
    v_max_f32 v63, 0, v63
    v_pk_mul_f32 v[62:63], v[62:63], v[62:63]
    v_cvt_pk_bf16_f32 v97, v62, v63
    v_max_f32 v64, 0, v64
    v_max_f32 v65, 0, v65
    v_pk_mul_f32 v[64:65], v[64:65], v[64:65]
    v_cvt_pk_bf16_f32 v98, v64, v65
    v_max_f32 v66, 0, v66
    v_max_f32 v67, 0, v67
    v_pk_mul_f32 v[66:67], v[66:67], v[66:67]
    v_cvt_pk_bf16_f32 v99, v66, v67
L_g_x:
    s_mov_b32 s61, 800000
L_pl0:
    ds_read_b32 v152, v164 offset:24
    s_waitcnt lgkmcnt(0)
    v_readfirstlane_b32 s12, v152
    s_nop 1
    s_cmp_eq_u32 s12, 8
    s_cbranch_scc1 L_pl0_ok
    s_sleep 2
    s_sub_u32 s61, s61, 1
    s_cmp_lg_u32 s61, 0
    s_cbranch_scc1 L_pl0
L_pl0_ok:
    s_setprio 0
    buffer_load_ushort v100, v161, s[48:51], s90 offen
    s_add_u32 m0, s58, 0
    s_nop 0
    buffer_load_dwordx4 v112, s[44:47], s56 offen lds
    buffer_load_dwordx4 v113, s[44:47], s56 offen offset:1024 lds
    s_add_u32 s56, s56, s57
    s_add_u32 m0, s58, 2048
    s_nop 0
    buffer_load_dwordx4 v112, s[44:47], s56 offen lds
    buffer_load_dwordx4 v113, s[44:47], s56 offen offset:1024 lds
    s_add_u32 s56, s56, s57
    s_cmp_eq_u32 s56, s91
    s_cselect_b32 s56, s90, s56
    s_add_u32 m0, s58, 4096
    s_nop 0
    buffer_load_dwordx4 v112, s[44:47], s56 offen lds
    buffer_load_dwordx4 v113, s[44:47], s56 offen offset:1024 lds
    s_add_u32 s56, s56, s57
    s_add_u32 m0, s58, 6144
    s_nop 0
    buffer_load_dwordx4 v112, s[44:47], s56 offen lds
    buffer_load_dwordx4 v113, s[44:47], s56 offen offset:1024 lds
    s_add_u32 s56, s56, s57
    s_cmp_eq_u32 s56, s91
    s_cselect_b32 s56, s90, s56
    s_lshl_b32 s92, s90, 6
    s_add_u32 s92, s92, s15
    s_lshl_b32 s12, s7, 10
    s_add_u32 s92, s92, s12
    s_mov_b32 s44, s32
    s_mov_b32 s45, s33
    s_mov_b32 s46, 1835008
    s_mov_b32 s47, 0x20000
    s_and_b32 s12, s43, 4
    s_mul_i32 s43, s43, 3
    s_add_u32 s43, s43, s12
    s_lshl_b32 s14, s5, 7
    s_mul_i32 s90, s7, 458752
    s_add_u32 s90, s90, s14
    s_mov_b32 s57, 16384
    s_add_u32 s91, s90, 458752
    s_lshl_b32 s12, s43, 14
    s_add_u32 s56, s90, s12
    s_add_u32 s42, s90, 196608
    s_cbranch_vccnz L_st0
    buffer_store_dwordx4 v[68:71], v153, s[8:11], s60 offen offset:0 sc1
L_std0:
    s_cbranch_vccnz L_st1
    buffer_store_dwordx4 v[72:75], v153, s[8:11], s60 offen offset:1024 sc1
L_std1:
    s_cbranch_vccnz L_st2
    buffer_store_dwordx4 v[76:79], v153, s[8:11], s60 offen offset:2048 sc1
L_std2:
    s_cbranch_vccnz L_st3
    buffer_store_dwordx4 v[80:83], v153, s[8:11], s60 offen offset:3072 sc1
L_std3:
    ds_read_b128 v[36:39], v162 offset:0
    ds_read_b128 v[40:43], v162 offset:33280
    ds_read_b128 v[44:47], v162 offset:32
    ds_read_b128 v[48:51], v162 offset:33312
    s_waitcnt vmcnt(4)
    ds_read_b64_tr_b16 v[132:133], v160 offset:0
    ds_read_b64_tr_b16 v[134:135], v160 offset:512
    ds_read_b64_tr_b16 v[136:137], v160 offset:1024
    ds_read_b64_tr_b16 v[138:139], v160 offset:1536
    v_mfma_f32_32x32x16_bf16 v[4:19], v[100:103], v[108:111], 0
    v_mfma_f32_32x32x16_bf16 v[20:35], v[100:103], v[108:111], 0
    s_waitcnt lgkmcnt(0)
    v_mfma_f32_32x32x16_bf16 v[4:19], v[132:135], v[36:39], v[4:19]
    ds_read_b64_tr_b16 v[140:141], v160 offset:2048
    ds_read_b64_tr_b16 v[142:143], v160 offset:2560
    ds_read_b64_tr_b16 v[144:145], v160 offset:3072
    ds_read_b64_tr_b16 v[146:147], v160 offset:3584
    v_mfma_f32_32x32x16_bf16 v[20:35], v[132:135], v[40:43], v[20:35]
    ds_read_b128 v[52:55], v162 offset:64
    ds_read_b128 v[56:59], v162 offset:33344
    ds_read_b128 v[60:63], v162 offset:96
    ds_read_b128 v[64:67], v162 offset:33376
    v_mfma_f32_32x32x16_bf16 v[4:19], v[136:139], v[44:47], v[4:19]
    v_mfma_f32_32x32x16_bf16 v[20:35], v[136:139], v[48:51], v[20:35]
    s_waitcnt vmcnt(3)
    s_cbranch_vccnz L_st4
    buffer_store_dwordx4 v[84:87], v153, s[8:11], s13 offen offset:0 sc1
L_std4:
    s_waitcnt lgkmcnt(0)
    v_mfma_f32_32x32x16_bf16 v[4:19], v[140:143], v[52:55], v[4:19]
    ds_read_b64_tr_b16 v[132:133], v160 offset:4096
    ds_read_b64_tr_b16 v[134:135], v160 offset:4608
    ds_read_b64_tr_b16 v[136:137], v160 offset:5120
    ds_read_b64_tr_b16 v[138:139], v160 offset:5632
    v_mfma_f32_32x32x16_bf16 v[20:35], v[140:143], v[56:59], v[20:35]
    ds_read_b128 v[36:39], v162 offset:128
    ds_read_b128 v[40:43], v162 offset:33408
    ds_read_b128 v[44:47], v162 offset:160
    ds_read_b128 v[48:51], v162 offset:33440
    v_mfma_f32_32x32x16_bf16 v[4:19], v[144:147], v[60:63], v[4:19]
    v_mfma_f32_32x32x16_bf16 v[20:35], v[144:147], v[64:67], v[20:35]
    s_waitcnt vmcnt(3)
    s_cbranch_vccnz L_st5
    buffer_store_dwordx4 v[88:91], v153, s[8:11], s13 offen offset:1024 sc1
L_std5:
    s_waitcnt lgkmcnt(0)
    v_mfma_f32_32x32x16_bf16 v[4:19], v[132:135], v[36:39], v[4:19]
    ds_read_b64_tr_b16 v[140:141], v160 offset:6144
    ds_read_b64_tr_b16 v[142:143], v160 offset:6656
    ds_read_b64_tr_b16 v[144:145], v160 offset:7168
    ds_read_b64_tr_b16 v[146:147], v160 offset:7680
    v_mfma_f32_32x32x16_bf16 v[20:35], v[132:135], v[40:43], v[20:35]
    ds_read_b128 v[52:55], v162 offset:192
    ds_read_b128 v[56:59], v162 offset:33472
    ds_read_b128 v[60:63], v162 offset:224
    ds_read_b128 v[64:67], v162 offset:33504
    v_mfma_f32_32x32x16_bf16 v[4:19], v[136:139], v[44:47], v[4:19]
    v_mfma_f32_32x32x16_bf16 v[20:35], v[136:139], v[48:51], v[20:35]
    s_waitcnt vmcnt(3)
    s_cbranch_vccnz L_st6
    buffer_store_dwordx4 v[92:95], v153, s[8:11], s13 offen offset:2048 sc1
L_std6:
    s_waitcnt lgkmcnt(0)
    v_mfma_f32_32x32x16_bf16 v[4:19], v[140:143], v[52:55], v[4:19]
    v_mfma_f32_32x32x16_bf16 v[20:35], v[140:143], v[56:59], v[20:35]
    v_mfma_f32_32x32x16_bf16 v[4:19], v[144:147], v[60:63], v[4:19]
    v_mfma_f32_32x32x16_bf16 v[20:35], v[144:147], v[64:67], v[20:35]
    s_waitcnt vmcnt(3)
    s_cbranch_vccnz L_st7
    buffer_store_dwordx4 v[96:99], v153, s[8:11], s13 offen offset:3072 sc1
L_std7:
    s_nop 11
    ds_write_b128 v114, v[4:7] offset:0
    ds_write_b128 v114, v[8:11] offset:1024
    ds_write_b128 v114, v[12:15] offset:4096
    ds_write_b128 v114, v[16:19] offset:5120
    ds_write_b128 v114, v[20:23] offset:2048
    ds_write_b128 v114, v[24:27] offset:3072
    ds_write_b128 v114, v[28:31] offset:6144
    ds_write_b128 v114, v[32:35] offset:7168
    s_mov_b64 exec, 1
    ds_add_u32 v164, v165 offset:16
    s_mov_b64 exec, -1
    s_setprio 3
    s_mov_b32 s61, 800000
L_px:
    ds_read_b32 v152, v164 offset:16
    s_waitcnt lgkmcnt(0)
    v_readfirstlane_b32 s12, v152
    s_nop 1
    s_cmp_eq_u32 s12, 4
    s_cbranch_scc1 L_px_ok
    s_sleep 3
    s_sub_u32 s61, s61, 1
    s_cmp_lg_u32 s61, 0
    s_cbranch_scc1 L_px
L_px_ok:
    ds_read_b128 v[4:7], v115 offset:0
    ds_read_b128 v[8:11], v115 offset:1024
    ds_read_b128 v[12:15], v115 offset:16384
    ds_read_b128 v[16:19], v115 offset:17408
    ds_read_b128 v[20:23], v115 offset:32768
    ds_read_b128 v[24:27], v115 offset:33792
    ds_read_b128 v[28:31], v115 offset:49152
    ds_read_b128 v[32:35], v115 offset:50176
    s_mov_b32 s48, s34
    s_mov_b32 s49, s35
    s_cmp_eq_u32 s7, 3
    s_cselect_b32 s50, 1024, 0
    buffer_load_ushort v100, v161, s[48:51], s14 offen
    buffer_load_ushort v104, v161, s[48:51], s14 offen offset:64
    s_mov_b64 exec, 1
    ds_add_u32 v164, v165 offset:28
    s_mov_b64 exec, -1
    s_waitcnt lgkmcnt(0)
    v_pk_add_f32 v[4:5], v[4:5], v[12:13]
    v_pk_add_f32 v[20:21], v[20:21], v[28:29]
    v_pk_add_f32 v[4:5], v[4:5], v[20:21]
    v_max_f32 v4, 0, v4
    v_max_f32 v5, 0, v5
    v_pk_mul_f32 v[4:5], v[4:5], v[4:5]
    v_cvt_pk_bf16_f32 v132, v4, v5
    v_pk_add_f32 v[6:7], v[6:7], v[14:15]
    v_pk_add_f32 v[22:23], v[22:23], v[30:31]
    v_pk_add_f32 v[6:7], v[6:7], v[22:23]
    v_max_f32 v6, 0, v6
    v_max_f32 v7, 0, v7
    v_pk_mul_f32 v[6:7], v[6:7], v[6:7]
    v_cvt_pk_bf16_f32 v133, v6, v7
    v_pk_add_f32 v[8:9], v[8:9], v[16:17]
    v_pk_add_f32 v[24:25], v[24:25], v[32:33]
    v_pk_add_f32 v[8:9], v[8:9], v[24:25]
    v_max_f32 v8, 0, v8
    v_max_f32 v9, 0, v9
    v_pk_mul_f32 v[8:9], v[8:9], v[8:9]
    v_cvt_pk_bf16_f32 v134, v8, v9
    v_pk_add_f32 v[10:11], v[10:11], v[18:19]
    v_pk_add_f32 v[26:27], v[26:27], v[34:35]
    v_pk_add_f32 v[10:11], v[10:11], v[26:27]
    v_max_f32 v10, 0, v10
    v_max_f32 v11, 0, v11
    v_pk_mul_f32 v[10:11], v[10:11], v[10:11]
    v_cvt_pk_bf16_f32 v135, v10, v11
    s_waitcnt vmcnt(2)
    s_mov_b64 exec, 1
    buffer_store_dword v163, v153, s[8:11], s93 offen sc1
    s_mov_b64 exec, -1
    buffer_store_dwordx4 v[132:135], v153, s[8:11], s92 offen sc1
    s_setprio 0
    s_mov_b32 s13, s14
    s_mov_b32 s52, s24
    s_mov_b32 s53, s25
    s_mov_b32 s54, 524288
    s_mov_b32 s55, 0x20000
    s_setprio 3
    v_mov_b32 v149, 8
    s_mov_b32 s61, 800000
L_pr2a:
    ds_read_b32 v152, v164 offset:28
    s_waitcnt lgkmcnt(0)
    v_readfirstlane_b32 s12, v152
    s_nop 1
    s_cmp_eq_u32 s12, 4
    s_cbranch_scc1 L_pr2a_ok
    s_sleep 2
    s_sub_u32 s61, s61, 1
    s_cmp_lg_u32 s61, 0
    s_cbranch_scc1 L_pr2a
L_pr2a_ok:
    s_setprio 0
    s_bfe_u32 s12, s2, 0x40003
    s_add_u32 s12, s12, 12
    s_and_b32 s12, s12, 15
    s_lshl_b32 s14, s7, 4
    s_add_u32 s12, s12, s14
    s_add_u32 m0, s58, 0
    s_lshl_b32 s12, s12, 11
    s_add_u32 s12, s12, 262144
    buffer_load_dwordx4 v153, s[8:11], s12 offen sc1 lds
    buffer_load_dwordx4 v153, s[8:11], s12 offen offset:1024 sc1 lds
    s_bfe_u32 s12, s2, 0x40003
    s_add_u32 s12, s12, 13
    s_and_b32 s12, s12, 15
    s_lshl_b32 s14, s7, 4
    s_add_u32 s12, s12, s14
    s_add_u32 m0, s58, 2048
    s_lshl_b32 s12, s12, 11
    s_add_u32 s12, s12, 262144
    buffer_load_dwordx4 v153, s[8:11], s12 offen sc1 lds
    buffer_load_dwordx4 v153, s[8:11], s12 offen offset:1024 sc1 lds
    s_bfe_u32 s12, s2, 0x40003
    s_add_u32 s12, s12, 14
    s_and_b32 s12, s12, 15
    s_lshl_b32 s14, s7, 4
    s_add_u32 s12, s12, s14
    s_add_u32 m0, s58, 4096
    s_lshl_b32 s12, s12, 11
    s_add_u32 s12, s12, 262144
    buffer_load_dwordx4 v153, s[8:11], s12 offen sc1 lds
    buffer_load_dwordx4 v153, s[8:11], s12 offen offset:1024 sc1 lds
    s_bfe_u32 s12, s2, 0x40003
    s_add_u32 s12, s12, 15
    s_and_b32 s12, s12, 15
    s_lshl_b32 s14, s7, 4
    s_add_u32 s12, s12, s14
    s_add_u32 m0, s58, 6144
    s_lshl_b32 s12, s12, 11
    s_add_u32 s12, s12, 262144
    buffer_load_dwordx4 v153, s[8:11], s12 offen sc1 lds
    buffer_load_dwordx4 v153, s[8:11], s12 offen offset:1024 sc1 lds
    s_mov_b32 s94, s4
    s_lshl_b32 s95, s7, 3
    s_add_u32 s93, s93, 458752
    s_waitcnt vmcnt(0)
    s_mov_b64 exec, 1
    buffer_store_dword v163, v153, s[8:11], s93 offen sc1
    s_mov_b64 exec, -1
    s_mov_b64 exec, 1
    ds_add_u32 v166, v149 offset:96
    s_mov_b64 exec, -1
    s_and_b32 s12, s94, 7
    s_add_u32 s12, s12, s95
    s_add_u32 s94, s94, 1
    s_lshl_b32 m0, s12, 11
    s_lshl_b32 s12, s12, 14
    s_add_u32 s12, s12, s13
    buffer_load_dwordx4 v116, s[52:55], s12 offen lds
    buffer_load_dwordx4 v117, s[52:55], s12 offen offset:1024 lds
    s_and_b32 s12, s94, 7
    s_add_u32 s12, s12, s95
    s_add_u32 s94, s94, 1
    s_lshl_b32 m0, s12, 11
    s_lshl_b32 s12, s12, 14
    s_add_u32 s12, s12, s13
    buffer_load_dwordx4 v116, s[52:55], s12 offen lds
    buffer_load_dwordx4 v117, s[52:55], s12 offen offset:1024 lds
    s_and_b32 s12, s94, 7
    s_add_u32 s12, s12, s95
    s_add_u32 s94, s94, 1
    s_lshl_b32 m0, s12, 11
    s_lshl_b32 s12, s12, 14
    s_add_u32 s12, s12, s13
    buffer_load_dwordx4 v116, s[52:55], s12 offen lds
    buffer_load_dwordx4 v117, s[52:55], s12 offen offset:1024 lds
    s_and_b32 s12, s94, 7
    s_add_u32 s12, s12, s95
    s_add_u32 s94, s94, 1
    s_lshl_b32 m0, s12, 11
    s_lshl_b32 s12, s12, 14
    s_add_u32 s12, s12, s13
    s_waitcnt vmcnt(4)
    buffer_load_dwordx4 v116, s[52:55], s12 offen lds
    buffer_load_dwordx4 v117, s[52:55], s12 offen offset:1024 lds
    s_and_b32 s12, s94, 7
    s_add_u32 s12, s12, s95
    s_add_u32 s94, s94, 1
    s_lshl_b32 m0, s12, 11
    s_lshl_b32 s12, s12, 14
    s_add_u32 s12, s12, s13
    s_waitcnt vmcnt(4)
    buffer_load_dwordx4 v116, s[52:55], s12 offen lds
    buffer_load_dwordx4 v117, s[52:55], s12 offen offset:1024 lds
    s_and_b32 s12, s94, 7
    s_add_u32 s12, s12, s95
    s_add_u32 s94, s94, 1
    s_lshl_b32 m0, s12, 11
    s_lshl_b32 s12, s12, 14
    s_add_u32 s12, s12, s13
    s_waitcnt vmcnt(4)
    buffer_load_dwordx4 v116, s[52:55], s12 offen lds
    buffer_load_dwordx4 v117, s[52:55], s12 offen offset:1024 lds
    s_and_b32 s12, s94, 7
    s_add_u32 s12, s12, s95
    s_add_u32 s94, s94, 1
    s_lshl_b32 m0, s12, 11
    s_lshl_b32 s12, s12, 14
    s_add_u32 s12, s12, s13
    s_waitcnt vmcnt(4)
    buffer_load_dwordx4 v116, s[52:55], s12 offen lds
    buffer_load_dwordx4 v117, s[52:55], s12 offen offset:1024 lds
    s_and_b32 s12, s94, 7
    s_add_u32 s12, s12, s95
    s_add_u32 s94, s94, 1
    s_lshl_b32 m0, s12, 11
    s_lshl_b32 s12, s12, 14
    s_add_u32 s12, s12, s13
    s_waitcnt vmcnt(4)
    buffer_load_dwordx4 v116, s[52:55], s12 offen lds
    buffer_load_dwordx4 v117, s[52:55], s12 offen offset:1024 lds
    v_mfma_f32_32x32x16_bf16 v[4:19], v[100:103], v[108:111], 0
    v_mfma_f32_32x32x16_bf16 v[20:35], v[104:107], v[108:111], 0
    v_mfma_f32_32x32x16_bf16 v[36:51], v[100:103], v[108:111], 0
    v_mfma_f32_32x32x16_bf16 v[52:67], v[104:107], v[108:111], 0
    s_mul_i32 s92, s7, 57344
    s_add_u32 s92, s92, s15
    s_add_u32 s93, s92, 57344
    s_lshl_b32 s12, s43, 11
    s_add_u32 s60, s92, s12
    s_add_u32 s97, s92, 24576
    s_lshl_b32 s14, s4, 2
    s_add_u32 s14, s14, s7
    s_lshl_b32 s14, s14, 10
    s_add_u32 s14, s14, 65536
    s_add_u32 m0, s58, 8192
    s_nop 0
    buffer_load_dwordx4 v154, s[44:47], s56 offen lds
    buffer_load_dwordx4 v155, s[44:47], s56 offen offset:1024 lds
    s_add_u32 s56, s56, s57
    s_cmp_eq_u32 s56, s91
    s_cselect_b32 s56, s90, s56
    s_cmp_eq_u32 s56, s42
    s_cselect_b32 s12, 65536, 0
    s_add_u32 s56, s56, s12
    s_add_u32 m0, s58, 10240
    s_nop 0
    buffer_load_dwordx4 v154, s[44:47], s56 offen lds
    buffer_load_dwordx4 v155, s[44:47], s56 offen offset:1024 lds
    s_add_u32 s56, s56, s57
    s_cmp_eq_u32 s56, s91
    s_cselect_b32 s56, s90, s56
    s_cmp_eq_u32 s56, s42
    s_cselect_b32 s12, 65536, 0
    s_add_u32 s56, s56, s12
    s_add_u32 m0, s58, 12288
    s_nop 0
    buffer_load_dwordx4 v154, s[44:47], s56 offen lds
    buffer_load_dwordx4 v155, s[44:47], s56 offen offset:1024 lds
    s_add_u32 s56, s56, s57
    s_cmp_eq_u32 s56, s91
    s_cselect_b32 s56, s90, s56
    s_cmp_eq_u32 s56, s42
    s_cselect_b32 s12, 65536, 0
    s_add_u32 s56, s56, s12
    s_mov_b32 s61, 200000
L_ph:
    s_setprio 0
    buffer_load_dword v152, v118, s[8:11], s14 offen sc1
    s_setprio 3
    s_waitcnt vmcnt(0)
    v_cmp_eq_u32 vcc, s6, v152
    s_nop 1
    s_cmp_eq_u64 vcc, -1
    s_cbranch_scc1 L_ph_ok
    s_sleep 8
    s_sub_u32 s61, s61, 1
    s_cmp_lg_u32 s61, 0
    s_cbranch_scc1 L_ph
L_ph_ok:
    s_setprio 0
    s_mov_b64 exec, 1
    ds_add_u32 v164, v165 offset:4
    s_mov_b64 exec, -1
    buffer_load_dwordx4 v[68:71], v153, s[8:11], s60 offen offset:0 sc1
    buffer_load_dwordx4 v[72:75], v153, s[8:11], s60 offen offset:1024 sc1
    s_add_u32 s60, s60, 2048
    s_cmp_eq_u32 s60, s93
    s_cselect_b32 s60, s92, s60
    s_cmp_eq_u32 s60, s97
    s_cselect_b32 s12, 8192, 0
    s_add_u32 s60, s60, s12
    buffer_load_dwordx4 v[76:79], v153, s[8:11], s60 offen offset:0 sc1
    buffer_load_dwordx4 v[80:83], v153, s[8:11], s60 offen offset:1024 sc1
    s_add_u32 s60, s60, 2048
    s_cmp_eq_u32 s60, s93
    s_cselect_b32 s60, s92, s60
    s_cmp_eq_u32 s60, s97
    s_cselect_b32 s12, 8192, 0
    s_add_u32 s60, s60, s12
    buffer_load_dwordx4 v[84:87], v153, s[8:11], s60 offen offset:0 sc1
    buffer_load_dwordx4 v[88:91], v153, s[8:11], s60 offen offset:1024 sc1
    s_add_u32 s60, s60, 2048
    s_cmp_eq_u32 s60, s93
    s_cselect_b32 s60, s92, s60
    s_cmp_eq_u32 s60, s97
    s_cselect_b32 s12, 8192, 0
    s_add_u32 s60, s60, s12
    ds_read_b64_tr_b16 v[132:133], v150 offset:8192
    ds_read_b64_tr_b16 v[134:135], v150 offset:9216
    ds_read_b64_tr_b16 v[136:137], v151 offset:8192
    ds_read_b64_tr_b16 v[138:139], v151 offset:9216
    s_mov_b32 s59, 5
    s_waitcnt vmcnt(0)
L_g2:
    s_waitcnt lgkmcnt(0)
    v_mfma_f32_32x32x16_bf16 v[4:19], v[132:135], v[68:71], v[4:19]
    s_waitcnt vmcnt(4)
    ds_read_b64_tr_b16 v[140:141], v150 offset:10240
    ds_read_b64_tr_b16 v[142:143], v150 offset:11264
    ds_read_b64_tr_b16 v[144:145], v151 offset:10240
    ds_read_b64_tr_b16 v[146:147], v151 offset:11264
    v_mfma_f32_32x32x16_bf16 v[20:35], v[136:139], v[68:71], v[20:35]
    buffer_load_dwordx4 v[92:95], v153, s[8:11], s60 offen offset:0 sc1
    v_mfma_f32_32x32x16_bf16 v[36:51], v[132:135], v[72:75], v[36:51]
    s_add_u32 m0, s58, 14336
    s_nop 0
    buffer_load_dwordx4 v154, s[44:47], s56 offen lds
    buffer_load_dwordx4 v155, s[44:47], s56 offen offset:1024 lds
    s_add_u32 s56, s56, s57
    s_cmp_eq_u32 s56, s91
    s_cselect_b32 s56, s90, s56
    s_cmp_eq_u32 s56, s42
    s_cselect_b32 s12, 65536, 0
    s_add_u32 s56, s56, s12
    v_mfma_f32_32x32x16_bf16 v[52:67], v[136:139], v[72:75], v[52:67]
    buffer_load_dwordx4 v[96:99], v153, s[8:11], s60 offen offset:1024 sc1
    s_add_u32 s60, s60, 2048
    s_cmp_eq_u32 s60, s93
    s_cselect_b32 s60, s92, s60
    s_cmp_eq_u32 s60, s97
    s_cselect_b32 s12, 8192, 0
    s_add_u32 s60, s60, s12
    s_waitcnt lgkmcnt(0)
    v_mfma_f32_32x32x16_bf16 v[4:19], v[140:143], v[76:79], v[4:19]
    s_waitcnt vmcnt(4)
    ds_read_b64_tr_b16 v[132:133], v150 offset:12288
    ds_read_b64_tr_b16 v[134:135], v150 offset:13312
    ds_read_b64_tr_b16 v[136:137], v151 offset:12288
    ds_read_b64_tr_b16 v[138:139], v151 offset:13312
    v_mfma_f32_32x32x16_bf16 v[20:35], v[144:147], v[76:79], v[20:35]
    buffer_load_dwordx4 v[68:71], v153, s[8:11], s60 offen offset:0 sc1
    v_mfma_f32_32x32x16_bf16 v[36:51], v[140:143], v[80:83], v[36:51]
    s_add_u32 m0, s58, 8192
    s_nop 0
    buffer_load_dwordx4 v154, s[44:47], s56 offen lds
    buffer_load_dwordx4 v155, s[44:47], s56 offen offset:1024 lds
    s_add_u32 s56, s56, s57
    s_cmp_eq_u32 s56, s91
    s_cselect_b32 s56, s90, s56
    s_cmp_eq_u32 s56, s42
    s_cselect_b32 s12, 65536, 0
    s_add_u32 s56, s56, s12
    v_mfma_f32_32x32x16_bf16 v[52:67], v[144:147], v[80:83], v[52:67]
    buffer_load_dwordx4 v[72:75], v153, s[8:11], s60 offen offset:1024 sc1
    s_add_u32 s60, s60, 2048
    s_cmp_eq_u32 s60, s93
    s_cselect_b32 s60, s92, s60
    s_cmp_eq_u32 s60, s97
    s_cselect_b32 s12, 8192, 0
    s_add_u32 s60, s60, s12
    s_waitcnt lgkmcnt(0)
    v_mfma_f32_32x32x16_bf16 v[4:19], v[132:135], v[84:87], v[4:19]
    s_waitcnt vmcnt(4)
    ds_read_b64_tr_b16 v[140:141], v150 offset:14336
    ds_read_b64_tr_b16 v[142:143], v150 offset:15360
    ds_read_b64_tr_b16 v[144:145], v151 offset:14336
    ds_read_b64_tr_b16 v[146:147], v151 offset:15360
    v_mfma_f32_32x32x16_bf16 v[20:35], v[136:139], v[84:87], v[20:35]
    buffer_load_dwordx4 v[76:79], v153, s[8:11], s60 offen offset:0 sc1
    v_mfma_f32_32x32x16_bf16 v[36:51], v[132:135], v[88:91], v[36:51]
    s_add_u32 m0, s58, 10240
    s_nop 0
    buffer_load_dwordx4 v154, s[44:47], s56 offen lds
    buffer_load_dwordx4 v155, s[44:47], s56 offen offset:1024 lds
    s_add_u32 s56, s56, s57
    s_cmp_eq_u32 s56, s91
    s_cselect_b32 s56, s90, s56
    s_cmp_eq_u32 s56, s42
    s_cselect_b32 s12, 65536, 0
    s_add_u32 s56, s56, s12
    v_mfma_f32_32x32x16_bf16 v[52:67], v[136:139], v[88:91], v[52:67]
    buffer_load_dwordx4 v[80:83], v153, s[8:11], s60 offen offset:1024 sc1
    s_add_u32 s60, s60, 2048
    s_cmp_eq_u32 s60, s93
    s_cselect_b32 s60, s92, s60
    s_cmp_eq_u32 s60, s97
    s_cselect_b32 s12, 8192, 0
    s_add_u32 s60, s60, s12
    s_waitcnt lgkmcnt(0)
    v_mfma_f32_32x32x16_bf16 v[4:19], v[140:143], v[92:95], v[4:19]
    s_waitcnt vmcnt(4)
    ds_read_b64_tr_b16 v[132:133], v150 offset:8192
    ds_read_b64_tr_b16 v[134:135], v150 offset:9216
    ds_read_b64_tr_b16 v[136:137], v151 offset:8192
    ds_read_b64_tr_b16 v[138:139], v151 offset:9216
    v_mfma_f32_32x32x16_bf16 v[20:35], v[144:147], v[92:95], v[20:35]
    buffer_load_dwordx4 v[84:87], v153, s[8:11], s60 offen offset:0 sc1
    v_mfma_f32_32x32x16_bf16 v[36:51], v[140:143], v[96:99], v[36:51]
    s_add_u32 m0, s58, 12288
    s_nop 0
    buffer_load_dwordx4 v154, s[44:47], s56 offen lds
    buffer_load_dwordx4 v155, s[44:47], s56 offen offset:1024 lds
    s_add_u32 s56, s56, s57
    s_cmp_eq_u32 s56, s91
    s_cselect_b32 s56, s90, s56
    s_cmp_eq_u32 s56, s42
    s_cselect_b32 s12, 65536, 0
    s_add_u32 s56, s56, s12
    v_mfma_f32_32x32x16_bf16 v[52:67], v[144:147], v[96:99], v[52:67]
    buffer_load_dwordx4 v[88:91], v153, s[8:11], s60 offen offset:1024 sc1
    s_add_u32 s60, s60, 2048
    s_cmp_eq_u32 s60, s93
    s_cselect_b32 s60, s92, s60
    s_cmp_eq_u32 s60, s97
    s_cselect_b32 s12, 8192, 0
    s_add_u32 s60, s60, s12
    s_sub_u32 s59, s59, 1
    s_cmp_lg_u32 s59, 0
    s_cbranch_scc1 L_g2
    s_waitcnt lgkmcnt(0)
    v_mfma_f32_32x32x16_bf16 v[4:19], v[132:135], v[68:71], v[4:19]
    s_waitcnt vmcnt(4)
    ds_read_b64_tr_b16 v[140:141], v150 offset:10240
    ds_read_b64_tr_b16 v[142:143], v150 offset:11264
    ds_read_b64_tr_b16 v[144:145], v151 offset:10240
    ds_read_b64_tr_b16 v[146:147], v151 offset:11264
    s_add_u32 s14, s14, 458752
    buffer_load_dword v152, v118, s[8:11], s14 offen sc1
    v_mfma_f32_32x32x16_bf16 v[20:35], v[136:139], v[68:71], v[20:35]
    buffer_load_dwordx4 v[92:95], v153, s[8:11], s60 offen offset:0 sc1
    v_mfma_f32_32x32x16_bf16 v[36:51], v[132:135], v[72:75], v[36:51]
    s_add_u32 m0, s58, 14336
    s_nop 0
    buffer_load_dwordx4 v154, s[44:47], s56 offen lds
    buffer_load_dwordx4 v155, s[44:47], s56 offen offset:1024 lds
    s_add_u32 s56, s56, s57
    s_cmp_eq_u32 s56, s91
    s_cselect_b32 s56, s90, s56
    s_cmp_eq_u32 s56, s42
    s_cselect_b32 s12, 65536, 0
    s_add_u32 s56, s56, s12
    v_mfma_f32_32x32x16_bf16 v[52:67], v[136:139], v[72:75], v[52:67]
    buffer_load_dwordx4 v[96:99], v153, s[8:11], s60 offen offset:1024 sc1
    s_add_u32 s60, s60, 2048
    s_cmp_eq_u32 s60, s93
    s_cselect_b32 s60, s92, s60
    s_cmp_eq_u32 s60, s97
    s_cselect_b32 s12, 8192, 0
    s_add_u32 s60, s60, s12
    s_waitcnt lgkmcnt(0)
    v_mfma_f32_32x32x16_bf16 v[4:19], v[140:143], v[76:79], v[4:19]
    s_waitcnt vmcnt(4)
    ds_read_b64_tr_b16 v[132:133], v150 offset:12288
    ds_read_b64_tr_b16 v[134:135], v150 offset:13312
    ds_read_b64_tr_b16 v[136:137], v151 offset:12288
    ds_read_b64_tr_b16 v[138:139], v151 offset:13312
    v_mfma_f32_32x32x16_bf16 v[20:35], v[144:147], v[76:79], v[20:35]
    s_waitcnt vmcnt(4)
    s_setprio 3
    v_cmp_eq_u32 vcc, s6, v152
    s_mov_b32 s56, s42
    s_mov_b32 s60, s97
    s_cmp_eq_u64 vcc, -1
    s_cbranch_scc0 L_f2w
L_f2d:
    s_setprio 0
    buffer_load_dwordx4 v[68:71], v153, s[8:11], s60 offen offset:0 sc1
    v_mfma_f32_32x32x16_bf16 v[36:51], v[140:143], v[80:83], v[36:51]
    s_add_u32 m0, s58, 8192
    s_nop 0
    buffer_load_dwordx4 v154, s[44:47], s56 offen lds
    buffer_load_dwordx4 v155, s[44:47], s56 offen offset:1024 lds
    s_add_u32 s56, s56, s57
    s_cmp_eq_u32 s56, s91
    s_cselect_b32 s56, s90, s56
    v_mfma_f32_32x32x16_bf16 v[52:67], v[144:147], v[80:83], v[52:67]
    buffer_load_dwordx4 v[72:75], v153, s[8:11], s60 offen offset:1024 sc1
    s_add_u32 s60, s60, 2048
    s_cmp_eq_u32 s60, s93
    s_cselect_b32 s60, s92, s60
    s_waitcnt lgkmcnt(0)
    v_mfma_f32_32x32x16_bf16 v[4:19], v[132:135], v[84:87], v[4:19]
    s_waitcnt vmcnt(4)
    ds_read_b64_tr_b16 v[140:141], v150 offset:14336
    ds_read_b64_tr_b16 v[142:143], v150 offset:15360
    ds_read_b64_tr_b16 v[144:145], v151 offset:14336
    ds_read_b64_tr_b16 v[146:147], v151 offset:15360
    v_mfma_f32_32x32x16_bf16 v[20:35], v[136:139], v[84:87], v[20:35]
    buffer_load_dwordx4 v[76:79], v153, s[8:11], s60 offen offset:0 sc1
    v_mfma_f32_32x32x16_bf16 v[36:51], v[132:135], v[88:91], v[36:51]
    s_add_u32 m0, s58, 10240
    s_nop 0
    buffer_load_dwordx4 v154, s[44:47], s56 offen lds
    buffer_load_dwordx4 v155, s[44:47], s56 offen offset:1024 lds
    s_add_u32 s56, s56, s57
    s_cmp_eq_u32 s56, s91
    s_cselect_b32 s56, s90, s56
    v_mfma_f32_32x32x16_bf16 v[52:67], v[136:139], v[88:91], v[52:67]
    buffer_load_dwordx4 v[80:83], v153, s[8:11], s60 offen offset:1024 sc1
    s_add_u32 s60, s60, 2048
    s_cmp_eq_u32 s60, s93
    s_cselect_b32 s60, s92, s60
    s_waitcnt lgkmcnt(0)
    v_mfma_f32_32x32x16_bf16 v[4:19], v[140:143], v[92:95], v[4:19]
    s_waitcnt vmcnt(4)
    ds_read_b64_tr_b16 v[132:133], v150 offset:8192
    ds_read_b64_tr_b16 v[134:135], v150 offset:9216
    ds_read_b64_tr_b16 v[136:137], v151 offset:8192
    ds_read_b64_tr_b16 v[138:139], v151 offset:9216
    v_mfma_f32_32x32x16_bf16 v[20:35], v[144:147], v[92:95], v[20:35]
    buffer_load_dwordx4 v[84:87], v153, s[8:11], s60 offen offset:0 sc1
    v_mfma_f32_32x32x16_bf16 v[36:51], v[140:143], v[96:99], v[36:51]
    s_add_u32 m0, s58, 12288
    s_nop 0
    buffer_load_dwordx4 v154, s[44:47], s56 offen lds
    buffer_load_dwordx4 v155, s[44:47], s56 offen offset:1024 lds
    s_add_u32 s56, s56, s57
    s_cmp_eq_u32 s56, s91
    s_cselect_b32 s56, s90, s56
    v_mfma_f32_32x32x16_bf16 v[52:67], v[144:147], v[96:99], v[52:67]
    buffer_load_dwordx4 v[88:91], v153, s[8:11], s60 offen offset:1024 sc1
    s_add_u32 s60, s60, 2048
    s_cmp_eq_u32 s60, s93
    s_cselect_b32 s60, s92, s60
    s_waitcnt lgkmcnt(0)
    v_mfma_f32_32x32x16_bf16 v[4:19], v[132:135], v[68:71], v[4:19]
    s_waitcnt vmcnt(4)
    ds_read_b64_tr_b16 v[140:141], v150 offset:10240
    ds_read_b64_tr_b16 v[142:143], v150 offset:11264
    ds_read_b64_tr_b16 v[144:145], v151 offset:10240
    ds_read_b64_tr_b16 v[146:147], v151 offset:11264
    v_mfma_f32_32x32x16_bf16 v[20:35], v[136:139], v[68:71], v[20:35]
    buffer_load_dwordx4 v[92:95], v153, s[8:11], s60 offen offset:0 sc1
    v_mfma_f32_32x32x16_bf16 v[36:51], v[132:135], v[72:75], v[36:51]
    s_add_u32 m0, s58, 14336
    s_nop 0
    buffer_load_dwordx4 v154, s[44:47], s56 offen lds
    buffer_load_dwordx4 v155, s[44:47], s56 offen offset:1024 lds
    s_add_u32 s56, s56, s57
    s_cmp_eq_u32 s56, s91
    s_cselect_b32 s56, s90, s56
    v_mfma_f32_32x32x16_bf16 v[52:67], v[136:139], v[72:75], v[52:67]
    buffer_load_dwordx4 v[96:99], v153, s[8:11], s60 offen offset:1024 sc1
    s_add_u32 s60, s60, 2048
    s_cmp_eq_u32 s60, s93
    s_cselect_b32 s60, s92, s60
    s_waitcnt lgkmcnt(0)
    v_mfma_f32_32x32x16_bf16 v[4:19], v[140:143], v[76:79], v[4:19]
    s_waitcnt vmcnt(4)
    ds_read_b64_tr_b16 v[132:133], v150 offset:12288
    ds_read_b64_tr_b16 v[134:135], v150 offset:13312
    ds_read_b64_tr_b16 v[136:137], v151 offset:12288
    ds_read_b64_tr_b16 v[138:139], v151 offset:13312
    v_mfma_f32_32x32x16_bf16 v[20:35], v[144:147], v[76:79], v[20:35]
    v_mfma_f32_32x32x16_bf16 v[36:51], v[140:143], v[80:83], v[36:51]
    v_mfma_f32_32x32x16_bf16 v[52:67], v[144:147], v[80:83], v[52:67]
    s_waitcnt lgkmcnt(0)
    v_mfma_f32_32x32x16_bf16 v[4:19], v[132:135], v[84:87], v[4:19]
    s_waitcnt vmcnt(0)
    ds_read_b64_tr_b16 v[140:141], v150 offset:14336
    ds_read_b64_tr_b16 v[142:143], v150 offset:15360
    ds_read_b64_tr_b16 v[144:145], v151 offset:14336
    ds_read_b64_tr_b16 v[146:147], v151 offset:15360
    v_mfma_f32_32x32x16_bf16 v[20:35], v[136:139], v[84:87], v[20:35]
    v_mfma_f32_32x32x16_bf16 v[36:51], v[132:135], v[88:91], v[36:51]
    v_mfma_f32_32x32x16_bf16 v[52:67], v[136:139], v[88:91], v[52:67]
    s_lshl_b32 s12, s4, 16
    s_lshl_b32 s59, s7, 14
    s_add_u32 s12, s12, s59
    s_add_u32 s12, s12, s13
    s_mov_b32 s48, s16
    s_mov_b32 s49, s17
    s_mov_b32 s50, 2097152
    s_mov_b32 s51, 0x20000
    buffer_load_dwordx2 v[100:101], v119, s[48:51], s12 offen offset:0
    buffer_load_dwordx2 v[102:103], v119, s[48:51], s12 offen offset:32
    buffer_load_dwordx2 v[104:105], v119, s[48:51], s12 offen offset:64
    buffer_load_dwordx2 v[106:107], v119, s[48:51], s12 offen offset:96
    s_waitcnt lgkmcnt(0)
    v_mfma_f32_32x32x16_bf16 v[4:19], v[140:143], v[92:95], v[4:19]
    v_mfma_f32_32x32x16_bf16 v[20:35], v[144:147], v[92:95], v[20:35]
    v_mfma_f32_32x32x16_bf16 v[36:51], v[140:143], v[96:99], v[36:51]
    v_mfma_f32_32x32x16_bf16 v[52:67], v[144:147], v[96:99], v[52:67]
L_g2e:
    s_setprio 3
    s_nop 3
    s_mov_b32 s61, 800000
L_pr2:
    ds_read_b32 v152, v164 offset:140
    s_waitcnt lgkmcnt(0)
    v_readfirstlane_b32 s12, v152
    s_nop 1
    s_cmp_eq_u32 s12, 8
    s_cbranch_scc1 L_pr2_ok
    s_sleep 4
    s_sub_u32 s61, s61, 1
    s_cmp_lg_u32 s61, 0
    s_cbranch_scc1 L_pr2
L_pr2_ok:
    s_setprio 0
    ds_write_b128 v120, v[4:7] offset:0
    ds_write_b128 v120, v[36:39] offset:8192
    ds_write_b128 v121, v[8:11] offset:0
    ds_write_b128 v121, v[40:43] offset:8192
    ds_write_b128 v122, v[12:15] offset:0
    ds_write_b128 v122, v[44:47] offset:8192
    ds_write_b128 v123, v[16:19] offset:0
    ds_write_b128 v123, v[48:51] offset:8192
    ds_write_b128 v124, v[20:23] offset:0
    ds_write_b128 v124, v[52:55] offset:8192
    ds_write_b128 v125, v[24:27] offset:0
    ds_write_b128 v125, v[56:59] offset:8192
    ds_write_b128 v126, v[28:31] offset:0
    ds_write_b128 v126, v[60:63] offset:8192
    ds_write_b128 v127, v[32:35] offset:0
    ds_write_b128 v127, v[64:67] offset:8192
    s_setprio 3
    s_mov_b64 exec, 1
    ds_add_u32 v164, v165 offset:20
    s_mov_b64 exec, -1
    s_mov_b32 s61, 800000
L_pr:
    ds_read_b32 v152, v164 offset:20
    s_waitcnt lgkmcnt(0)
    v_readfirstlane_b32 s12, v152
    s_nop 1
    s_cmp_eq_u32 s12, 4
    s_cbranch_scc1 L_pr_ok
    s_sleep 4
    s_sub_u32 s61, s61, 1
    s_cmp_lg_u32 s61, 0
    s_cbranch_scc1 L_pr
L_pr_ok:
    s_setprio 0
    ds_read_b128 v[4:7], v128 offset:0
    ds_read_b128 v[20:23], v128 offset:16384
    ds_read_b128 v[36:39], v128 offset:32768
    ds_read_b128 v[52:55], v128 offset:49152
    ds_read_b128 v[8:11], v129 offset:0
    ds_read_b128 v[24:27], v129 offset:16384
    ds_read_b128 v[40:43], v129 offset:32768
    ds_read_b128 v[56:59], v129 offset:49152
    ds_read_b128 v[12:15], v130 offset:0
    ds_read_b128 v[28:31], v130 offset:16384
    ds_read_b128 v[44:47], v130 offset:32768
    ds_read_b128 v[60:63], v130 offset:49152
    ds_read_b128 v[16:19], v131 offset:0
    ds_read_b128 v[32:35], v131 offset:16384
    ds_read_b128 v[48:51], v131 offset:32768
    ds_read_b128 v[64:67], v131 offset:49152
    s_setprio 1
    s_waitcnt lgkmcnt(0)
    s_barrier
    s_waitcnt vmcnt(0)
    v_lshlrev_b32 v68, 16, v100
    v_and_b32 v69, 0xffff0000, v100
    v_lshlrev_b32 v70, 16, v101
    v_and_b32 v71, 0xffff0000, v101
    v_lshlrev_b32 v72, 16, v102
    v_and_b32 v73, 0xffff0000, v102
    v_lshlrev_b32 v74, 16, v103
    v_and_b32 v75, 0xffff0000, v103
    v_lshlrev_b32 v76, 16, v104
    v_and_b32 v77, 0xffff0000, v104
    v_lshlrev_b32 v78, 16, v105
    v_and_b32 v79, 0xffff0000, v105
    v_lshlrev_b32 v80, 16, v106
    v_and_b32 v81, 0xffff0000, v106
    v_lshlrev_b32 v82, 16, v107
    v_and_b32 v83, 0xffff0000, v107
    s_waitcnt lgkmcnt(12)
    v_pk_add_f32 v[20:21], v[20:21], v[4:5]
    v_pk_add_f32 v[36:37], v[36:37], v[52:53]
    v_pk_add_f32 v[20:21], v[20:21], v[36:37]
    v_pk_add_f32 v[22:23], v[22:23], v[6:7]
    v_pk_add_f32 v[38:39], v[38:39], v[54:55]
    v_pk_add_f32 v[22:23], v[22:23], v[38:39]
    s_waitcnt lgkmcnt(8)
    v_pk_add_f32 v[24:25], v[24:25], v[8:9]
    v_pk_add_f32 v[40:41], v[40:41], v[56:57]
    v_pk_add_f32 v[24:25], v[24:25], v[40:41]
    v_pk_add_f32 v[26:27], v[26:27], v[10:11]
    v_pk_add_f32 v[42:43], v[42:43], v[58:59]
    v_pk_add_f32 v[26:27], v[26:27], v[42:43]
    s_waitcnt lgkmcnt(4)
    v_pk_add_f32 v[28:29], v[28:29], v[12:13]
    v_pk_add_f32 v[44:45], v[44:45], v[60:61]
    v_pk_add_f32 v[28:29], v[28:29], v[44:45]
    v_pk_add_f32 v[30:31], v[30:31], v[14:15]
    v_pk_add_f32 v[46:47], v[46:47], v[62:63]
    v_pk_add_f32 v[30:31], v[30:31], v[46:47]
    s_waitcnt lgkmcnt(0)
    v_pk_add_f32 v[32:33], v[32:33], v[16:17]
    v_pk_add_f32 v[48:49], v[48:49], v[64:65]
    v_pk_add_f32 v[32:33], v[32:33], v[48:49]
    v_pk_add_f32 v[34:35], v[34:35], v[18:19]
    v_pk_add_f32 v[50:51], v[50:51], v[66:67]
    v_pk_add_f32 v[34:35], v[34:35], v[50:51]
    ds_write_b128 v167, v[68:71] offset:16384
    ds_write_b128 v167, v[72:75] offset:17408
    ds_write_b128 v167, v[76:79] offset:18432
    ds_write_b128 v167, v[80:83] offset:19456
    v_mul_f32 v36, 0xbfb8aa3b, v20
    v_mul_f32 v37, 0xbfb8aa3b, v21
    v_mul_f32 v38, 0xbfb8aa3b, v22
    v_mul_f32 v39, 0xbfb8aa3b, v23
    v_mul_f32 v40, 0xbfb8aa3b, v24
    v_mul_f32 v41, 0xbfb8aa3b, v25
    v_mul_f32 v42, 0xbfb8aa3b, v26
    v_mul_f32 v43, 0xbfb8aa3b, v27
    v_mul_f32 v44, 0xbfb8aa3b, v28
    v_mul_f32 v45, 0xbfb8aa3b, v29
    v_mul_f32 v46, 0xbfb8aa3b, v30
    v_mul_f32 v47, 0xbfb8aa3b, v31
    v_mul_f32 v48, 0xbfb8aa3b, v32
    v_mul_f32 v49, 0xbfb8aa3b, v33
    v_mul_f32 v50, 0xbfb8aa3b, v34
    v_mul_f32 v51, 0xbfb8aa3b, v35
    v_exp_f32 v36, v36
    v_exp_f32 v37, v37
    v_exp_f32 v38, v38
    v_exp_f32 v39, v39
    v_exp_f32 v40, v40
    v_exp_f32 v41, v41
    v_exp_f32 v42, v42
    v_exp_f32 v43, v43
    v_exp_f32 v44, v44
    v_exp_f32 v45, v45
    v_exp_f32 v46, v46
    v_exp_f32 v47, v47
    v_exp_f32 v48, v48
    v_exp_f32 v49, v49
    v_exp_f32 v50, v50
    v_exp_f32 v51, v51
    v_add_f32 v36, 1.0, v36
    v_add_f32 v37, 1.0, v37
    v_add_f32 v38, 1.0, v38
    v_add_f32 v39, 1.0, v39
    v_add_f32 v40, 1.0, v40
    v_add_f32 v41, 1.0, v41
    v_add_f32 v42, 1.0, v42
    v_add_f32 v43, 1.0, v43
    v_add_f32 v44, 1.0, v44
    v_add_f32 v45, 1.0, v45
    v_add_f32 v46, 1.0, v46
    v_add_f32 v47, 1.0, v47
    v_add_f32 v48, 1.0, v48
    v_add_f32 v49, 1.0, v49
    v_add_f32 v50, 1.0, v50
    v_add_f32 v51, 1.0, v51
    v_rcp_f32 v36, v36
    v_rcp_f32 v37, v37
    v_rcp_f32 v38, v38
    v_rcp_f32 v39, v39
    v_rcp_f32 v40, v40
    v_rcp_f32 v41, v41
    v_rcp_f32 v42, v42
    v_rcp_f32 v43, v43
    v_rcp_f32 v44, v44
    v_rcp_f32 v45, v45
    v_rcp_f32 v46, v46
    v_rcp_f32 v47, v47
    v_rcp_f32 v48, v48
    v_rcp_f32 v49, v49
    v_rcp_f32 v50, v50
    v_rcp_f32 v51, v51
    v_mul_f32 v20, v20, v36
    v_mul_f32 v21, v21, v37
    v_mul_f32 v22, v22, v38
    v_mul_f32 v23, v23, v39
    v_mul_f32 v24, v24, v40
    v_mul_f32 v25, v25, v41
    v_mul_f32 v26, v26, v42
    v_mul_f32 v27, v27, v43
    v_mul_f32 v28, v28, v44
    v_mul_f32 v29, v29, v45
    v_mul_f32 v30, v30, v46
    v_mul_f32 v31, v31, v47
    v_mul_f32 v32, v32, v48
    v_mul_f32 v33, v33, v49
    v_mul_f32 v34, v34, v50
    v_mul_f32 v35, v35, v51
    ds_write_b128 v167, v[20:23] offset:0
    ds_write_b128 v167, v[24:27] offset:1024
    ds_write_b128 v167, v[28:31] offset:2048
    ds_write_b128 v167, v[32:35] offset:3072
    ds_write_b32 v166, v165 offset:48
    s_waitcnt lgkmcnt(0)
L_exit:
    s_endpgm
L_f2w:
    s_mov_b32 s61, 200000
L_pf2:
    buffer_load_dword v152, v118, s[8:11], s14 offen sc1
    s_waitcnt vmcnt(0)
    v_cmp_eq_u32 vcc, s6, v152
    s_nop 1
    s_cmp_eq_u64 vcc, -1
    s_cbranch_scc1 L_pf2_ok
    s_sleep 8
    s_sub_u32 s61, s61, 1
    s_cmp_lg_u32 s61, 0
    s_cbranch_scc1 L_pf2
L_pf2_ok:
    s_branch L_f2d
L_st0:
    buffer_store_dwordx4 v[156:159], v153, s[8:11], s60 offen offset:0 sc1
    s_branch L_std0
L_st1:
    buffer_store_dwordx4 v[156:159], v153, s[8:11], s60 offen offset:1024 sc1
    s_branch L_std1
L_st2:
    buffer_store_dwordx4 v[156:159], v153, s[8:11], s60 offen offset:2048 sc1
    s_branch L_std2
L_st3:
    buffer_store_dwordx4 v[156:159], v153, s[8:11], s60 offen offset:3072 sc1
    s_branch L_std3
L_st4:
    buffer_store_dwordx4 v[156:159], v153, s[8:11], s13 offen offset:0 sc1
    s_branch L_std4
L_st5:
    buffer_store_dwordx4 v[156:159], v153, s[8:11], s13 offen offset:1024 sc1
    s_branch L_std5
L_st6:
    buffer_store_dwordx4 v[156:159], v153, s[8:11], s13 offen offset:2048 sc1
    s_branch L_std6
L_st7:
    buffer_store_dwordx4 v[156:159], v153, s[8:11], s13 offen offset:3072 sc1
    s_branch L_std7
L_codeend:
.section .rodata,"a"
.p2align 6
.amdhsa_kernel recurrent_scan__grouped_kv_mqa__dense_activation_squared_relu__prompt_kernel
  .amdhsa_next_free_vgpr 168
  .amdhsa_next_free_sgpr 98
  .amdhsa_accum_offset 168
  .amdhsa_group_segment_fixed_size 0
  .amdhsa_kernarg_size 104
  .amdhsa_user_sgpr_count 2
  .amdhsa_user_sgpr_kernarg_segment_ptr 1
  .amdhsa_system_sgpr_workgroup_id_x 1
.end_amdhsa_kernel
```
